```python
import torch

def _softmax(x, axis=-1):
    return torch.softmax(x, dim=axis)
def _gelu(x):
    return torch.nn.functional.gelu(x, approximate="tanh")
def _silu(x):
    return torch.nn.functional.silu(x)
def _sigmoid(x):
    return torch.sigmoid(x)
def _layernorm(x, axis=-1, eps=1e-5):
    m = x.mean(dim=axis, keepdim=True)
    v = x.var(dim=axis, keepdim=True, unbiased=False)
    return (x - m) / torch.sqrt(v + eps)
def _scatter_add(tgt, idx, src, axis=0):
    return tgt.clone().index_add_(axis, idx, src)
def _segment_sum(src, seg, n):
    out = torch.zeros((n,) + src.shape[1:], dtype=src.dtype)
    return out.index_add_(0, seg, src)
def _pad(x, pw):
    flat = tuple(v for pair in reversed(pw) for v in pair)
    return torch.nn.functional.pad(x, flat)

kernel_name = 'parallel_sum__linear_kernel_hedgehog__dense_activation_gelu__prompt'

def setup_inputs():

    _w = (lambda a: (lambda t: t.to(torch.bfloat16) if t.is_floating_point() else t)(torch.as_tensor(a)))
    def _A_setup():
        B, S, D, H = 1, 2048, 512, 32
        Dh = D // H
        return {
            "x": _w((lambda *s: torch.randn(*s, dtype=torch.bfloat16) * 0.05)(B, S, D)),
            "wqkv": _w((lambda *s: torch.randn(*s, dtype=torch.bfloat16) * 0.2)(D, 3 * D)),
            "w_phi": _w((lambda *s: torch.randn(*s, dtype=torch.bfloat16) * 0.2)(H, Dh, Dh) * (Dh ** -0.5)),
            "wo": _w((lambda *s: torch.randn(*s, dtype=torch.bfloat16) * 0.05)(D, D)),
        }
    _A_in = _A_setup()

    def _B_setup():
        B, S, D, F = 1, 2048, 512, 1792
        return {
            "x": _w((lambda *s: torch.randn(*s, dtype=torch.bfloat16) * 0.05)(B, S, D)),
            "w1": _w((lambda *s: torch.randn(*s, dtype=torch.bfloat16) * 0.8)(D, F) * (D ** -0.5)),
            "b1": _w((lambda *s: torch.randn(*s, dtype=torch.bfloat16) * 12.8)(F) * 0.01),
            "w2": _w((lambda *s: torch.randn(*s, dtype=torch.bfloat16) * 0.4)(F, D) * (F ** -0.5)),
            "b2": _w((lambda *s: torch.randn(*s, dtype=torch.bfloat16) * 6.4)(D) * 0.01),
        }
    _B_in = _B_setup()

    return {
        "A_x": _A_in["x"],
        "A_wqkv": _A_in["wqkv"],
        "A_w_phi": _A_in["w_phi"],
        "A_wo": _A_in["wo"],
        "B_x": _B_in["x"],
        "B_w1": _B_in["w1"],
        "B_b1": _B_in["b1"],
        "B_w2": _B_in["w2"],
        "B_b2": _B_in["b2"],
    }

def reference(A_x, A_wqkv, A_w_phi, A_wo, B_x, B_w1, B_b1, B_w2, B_b2):
    def _A_ref(x, wqkv, w_phi, wo):
        B, S, D = x.shape
        H = 32; Dh = D // H
        qkv = (lambda x, *d: x.permute(*d))((x @ wqkv).reshape(B, S, 3, H, Dh), 2, 0, 3, 1, 4)
        q, k, v = qkv[0], qkv[1], qkv[2]
        pq = torch.einsum("bhsd,hdf->bhsf", q, w_phi)
        pk = torch.einsum("bhsd,hdf->bhsf", k, w_phi)
        phi_q = torch.concatenate([_softmax(pq, axis=-1), _softmax(-pq, axis=-1)], axis=-1)
        phi_k = torch.concatenate([_softmax(pk, axis=-1), _softmax(-pk, axis=-1)], axis=-1)
        kv = torch.einsum("bhsf,bhsd->bhfd", phi_k, v)
        z  = torch.einsum("bhsf->bhf", phi_k)
        num = torch.einsum("bhqf,bhfd->bhqd", phi_q, kv)
        den = torch.einsum("bhqf,bhf->bhq", phi_q, z)[..., None] + 1e-6
        o = num / den
        return (lambda x, *d: x.permute(*d))(o, 0, 2, 1, 3).reshape(B, S, D) @ wo

    def _B_ref(x, w1, b1, w2, b2):
        h = torch.einsum("bsd,df->bsf", x, w1) + b1
        h = _gelu(h)
        return torch.einsum("bsf,fd->bsd", h, w2) + b2

    x = A_x
    xn = _layernorm(x, axis=-1)
    return x + _A_ref(xn, A_wqkv, A_w_phi, A_wo) + _B_ref(xn, B_w1, B_b1, B_w2, B_b2)
```

```asm
; @launch grid=(256,1,1) block=(512,1,1) lds=163840
.amdgcn_target "amdgcn-amd-amdhsa--gfx950"
.text
.globl parallel_sum__linear_kernel_hedgehog__dense_activation_gelu__prompt_kernel
.p2align 8
.type parallel_sum__linear_kernel_hedgehog__dense_activation_gelu__prompt_kernel,@function
parallel_sum__linear_kernel_hedgehog__dense_activation_gelu__prompt_kernel:
    s_cmp_ge_u32 s2, 256
    s_cbranch_scc1 L_end
    s_load_dwordx2 s[8:9], s[0:1], 0
    s_load_dwordx2 s[20:21], s[0:1], 8
    s_load_dwordx2 s[96:97], s[0:1], 40
    v_lshrrev_b32 v2, 6, v0
    v_and_b32 v1, 63, v0
    s_lshr_b32 s48, s2, 3
    v_readfirstlane_b32 s3, v2
    s_and_b32 s4, s2, 4
    s_lshl_b32 s4, s4, 1
    s_and_b32 s56, s48, 7
    s_add_u32 s4, s4, s56
    v_lshrrev_b32 v2, 3, v1
    v_and_b32 v3, 7, v1
    v_lshrrev_b32 v4, 4, v1
    s_lshl_b32 s32, s4, 17
    s_lshl_b32 s56, s3, 14
    s_add_u32 s32, s32, s56
    v_xor_b32 v5, v3, v4
    v_lshl_add_u32 v5, v5, 4, s32
    v_lshl_add_u32 v14, v2, 10, v5
    s_lshr_b32 s7, s48, 3
    s_lshl_b32 s56, s7, 1
    s_add_u32 s34, s4, s56
    s_and_b32 s34, s34, 7
    v_xor_b32 v5, 64, v14
    v_add_u32 v15, 7168, v5
    s_mov_b32 s10, 2097152
    s_mov_b32 s11, 0x20000
    s_lshl_b32 s46, s3, 11
    s_lshl_b32 s65, s34, 7
    s_mov_b32 m0, s46
    v_and_b32 v4, 1, v4
    v_lshlrev_b32 v4, 2, v4
    v_xor_b32 v4, v3, v4
    v_lshlrev_b32 v4, 4, v4
    s_and_b32 s6, s2, 3
    s_lshl_b32 s5, s6, 1
    s_lshr_b32 s56, s48, 4
    s_add_u32 s5, s5, s56
    s_lshr_b32 s100, s46, 1
    s_waitcnt lgkmcnt(0)
    buffer_load_dwordx4 v14, s[8:11], s65 offen lds
    buffer_load_dwordx4 v15, s[8:11], s65 offen offset:1024 lds
    s_load_dwordx2 s[16:17], s[0:1], 88
    s_load_dwordx2 s[28:29], s[0:1], 80
    s_load_dwordx2 s[12:13], s[0:1], 56
    s_load_dwordx2 s[36:37], s[0:1], 24
    s_load_dwordx2 s[40:41], s[0:1], 72
    s_load_dwordx2 s[92:93], s[0:1], 64
    s_bitcmp1_b32 s48, 3
    s_cbranch_scc1 L_ffn
    s_load_dwordx2 s[24:25], s[0:1], 16
    s_mov_b32 s22, 1572864
    s_mov_b32 s23, 0x20000
    v_mul_u32_u24 v16, 3072, v2
    v_add_u32 v16, v16, v4
    s_lshl_b32 s54, s5, 7
    s_mul_i32 s33, s3, 24576
    s_add_u32 s33, s33, s54
    s_add_u32 s33, s33, 1024
    v_add_u32 v22, s33, v16
    s_mul_i32 s101, s65, 1536
    s_add_u32 m0, s100, 65536
    s_add_u32 s65, s65, 128
    buffer_load_dwordx4 v22, s[20:23], s101 offen lds
    s_and_b32 s65, s65, 1023
    s_waitcnt lgkmcnt(0)
    s_mov_b32 s18, 25165824
    s_mov_b32 s19, 0x20000
    s_mov_b32 s30, 256
    s_mov_b32 s31, 0x20000
    s_mov_b32 s14, 1835008
    s_mov_b32 s15, 0x20000
    s_mov_b32 s38, 524288
    s_mov_b32 s39, 0x20000
    s_mov_b32 s42, 2097152
    s_mov_b32 s43, 0x20000
    s_mov_b32 s94, 1024
    s_mov_b32 s95, 0x20000
    s_mov_b32 s26, 16384
    s_mov_b32 s27, 0x20000
    v_lshlrev_b32 v27, 4, v1
    s_lshr_b32 s52, s3, 2
    s_and_b32 s58, s3, 3
    s_xor_b32 s49, s58, s52
    v_mov_b32 v44, 0
    v_mov_b32 v45, 0
    v_mov_b32 v46, 0
    v_mov_b32 v47, 0
    s_lshl_b32 s47, s3, 8
    s_add_u32 s47, s47, s2
    s_sub_u32 s47, s47, 256
    s_cmp_lt_u32 s47, 8
    s_cbranch_scc0 L_nzero
    s_lshl_b32 s47, s2, 12
    s_add_u32 s47, s47, 12582912
    buffer_store_dwordx4 v[44:47], v27, s[16:19], s47 offen offset:0 sc1
    buffer_store_dwordx4 v[44:47], v27, s[16:19], s47 offen offset:1024 sc1
    buffer_store_dwordx4 v[44:47], v27, s[16:19], s47 offen offset:2048 sc1
    buffer_store_dwordx4 v[44:47], v27, s[16:19], s47 offen offset:3072 sc1
    s_lshl_b32 s47, s2, 8
    s_add_u32 s47, s47, 12615680
    v_lshlrev_b32 v3, 2, v1
    buffer_store_dword v44, v3, s[16:19], s47 offen sc1
L_nzero:
    s_mov_b32 s57, 0x7f000000
    s_sub_u32 s47, s3, 2
    s_cmp_lt_u32 s47, 2
    s_cbranch_scc0 L_nwa
    v_mul_u32_u24 v3, 3072, v1
    s_mul_i32 s48, s34, 196608
    s_add_u32 s48, s48, s54
    s_xor_b32 s47, s47, 1
    s_lshl_b32 s47, s47, 11
    s_add_u32 s48, s48, s47
    s_mov_b32 s57, s48
L_nwa:
    s_cmp_eq_u32 s3, 5
    s_cbranch_scc0 L_ncpa
    s_getpc_b64 s[60:61]
L_pca:
    s_sub_u32 s60, s60, L_pca-parallel_sum__linear_kernel_hedgehog__dense_activation_gelu__prompt_kernel
    s_subb_u32 s61, s61, 0
    s_lshr_b32 s47, s2, 3
    s_lshl_b32 s47, s47, 11
    v_and_b32 v3, 15, v1
    v_lshlrev_b32 v3, 7, v3
    v_add_u32 v3, s47, v3
    v_min_u32 v3, L_end-parallel_sum__linear_kernel_hedgehog__dense_activation_gelu__prompt_kernel, v3
    global_load_dword v253, v3, s[60:61]
L_ncpa:
    s_add_u32 m0, s46, 16384
    s_mul_i32 s101, s65, 1536
    buffer_load_dwordx4 v14, s[8:11], s65 offen lds
    buffer_load_dwordx4 v15, s[8:11], s65 offen offset:1024 lds
    s_add_u32 m0, s100, 73728
    s_add_u32 s65, s65, 128
    buffer_load_dwordx4 v22, s[20:23], s101 offen lds
    s_and_b32 s65, s65, 1023
    s_lshl_b32 s47, s4, 4
    s_add_u32 s47, s47, s5
    s_lshl_b32 s47, s47, 7
    s_and_b32 s48, s3, 2
    s_lshl_b32 s48, s48, 3
    s_add_u32 s47, s47, s48
    s_and_b32 s48, s3, 1
    s_lshl_b32 s48, s48, 2
    s_add_u32 s47, s47, s48
    s_lshl_b32 s48, s52, 3
    s_add_u32 s47, s47, s48
    s_add_u32 s51, s47, 12582912
    s_lshl_b32 s47, s4, 2
    s_add_u32 s47, s47, s58
    s_mul_i32 s53, s47, 147456
    s_cmp_lt_u32 s3, 2
    s_cbranch_scc0 L_nphi
    s_lshl_b32 s47, s5, 11
    s_lshl_b32 s48, s3, 10
    s_add_u32 s47, s47, s48
    s_add_u32 m0, s48, 161792
    s_nop 0
    buffer_load_dwordx4 v27, s[24:27], s47 offen lds
L_nphi:
    s_mov_b64 s[24:25], s[96:97]
    s_mov_b32 s26, 1835008
    s_mul_i32 s47, s58, 49152
    s_add_u32 s54, s54, s47
    v_add_u32 v16, s54, v16
    s_add_u32 s47, s34, s52
    s_add_u32 s48, s47, 0
    s_and_b32 s48, s48, 7
    s_mul_i32 s32, s48, 196608
    s_add_u32 s48, s47, 2
    s_and_b32 s48, s48, 7
    s_mul_i32 s33, s48, 196608
    s_add_u32 s48, s47, 4
    s_and_b32 s48, s48, 7
    s_mul_i32 s34, s48, 196608
    s_add_u32 s48, s47, 6
    s_and_b32 s48, s48, 7
    s_mul_i32 s35, s48, 196608
    s_mov_b32 s59, 0x3b000000
    s_mov_b32 s50, 0x3f803f80
    v_bfe_u32 v44, v1, 2, 2
    v_lshrrev_b32 v45, 5, v1
    v_bfe_u32 v46, v1, 4, 1
    v_lshlrev_b32 v46, 5, v46
    v_and_b32 v47, 3, v1
    v_lshl_add_u32 v46, v47, 3, v46
    v_and_b32 v48, 31, v1
    v_bfe_u32 v49, v1, 1, 3
    v_xor_b32 v49, v49, v45
    s_lshl_b32 s47, s58, 12
    v_lshlrev_b32 v52, 7, v48
    v_add_u32 v52, s47, v52
    v_lshl_add_u32 v53, v45, 3, v44
    v_lshl_add_u32 v54, v53, 7, v46
    v_lshrrev_b32 v51, 1, v44
    v_xor_b32 v51, s52, v51
    v_lshl_add_u32 v54, v51, 6, v54
    s_xor_b32 s47, s49, 0
    s_lshl_b32 s48, s47, 1
    v_xor_b32 v50, s48, v49
    v_lshl_add_u32 v2, v50, 4, v52
    s_lshl_b32 s48, s47, 11
    s_add_u32 s48, s48, 65536
    v_add_u32 v6, s48, v54
    s_xor_b32 s47, s49, 1
    s_lshl_b32 s48, s47, 1
    v_xor_b32 v50, s48, v49
    v_lshl_add_u32 v3, v50, 4, v52
    s_lshl_b32 s48, s47, 11
    s_add_u32 s48, s48, 65536
    v_add_u32 v7, s48, v54
    s_xor_b32 s47, s49, 2
    s_lshl_b32 s48, s47, 1
    v_xor_b32 v50, s48, v49
    v_lshl_add_u32 v4, v50, 4, v52
    s_lshl_b32 s48, s47, 11
    s_add_u32 s48, s48, 65536
    v_add_u32 v8, s48, v54
    s_xor_b32 s47, s49, 3
    s_lshl_b32 s48, s47, 1
    v_xor_b32 v50, s48, v49
    v_lshl_add_u32 v5, v50, 4, v52
    s_lshl_b32 s48, s47, 11
    s_add_u32 s48, s48, 65536
    v_add_u32 v9, s48, v54
    v_lshlrev_b32 v48, 4, v48
    s_lshl_b32 s47, s52, 9
    s_add_u32 s47, s47, 155648
    v_add_u32 v0, s47, v48
    s_lshl_b32 s47, s58, 9
    s_add_u32 s47, s47, 159744
    v_add_u32 v19, s47, v48
    v_lshrrev_b32 v48, 2, v1
    v_xor_b32 v48, v48, v1
    v_and_b32 v48, 4, v48
    v_cmp_eq_u32 vcc, 0, v48
    v_mov_b32 v48, s50
    v_mov_b32 v120, -1
    v_mov_b32 v121, -1
    v_mov_b32 v122, -1
    v_mov_b32 v123, -1
    v_mov_b32 v12, 0
    v_mov_b32 v31, 0
    v_mov_b32 v34, 0
    v_mov_b32 v35, 0
    v_cndmask_b32 v36, 0, v48, vcc
    v_cndmask_b32 v37, 0, v48, vcc
    v_cndmask_b32 v38, 0, v48, vcc
    v_cndmask_b32 v39, 0, v48, vcc
    s_lshl_b32 s58, s58, 2
    v_lshrrev_b32 v44, 4, v1
    v_lshlrev_b32 v45, 2, v44
    v_and_b32 v46, 15, v1
    v_xor_b32 v46, v46, v45
    v_lshlrev_b32 v46, 4, v46
    v_lshl_add_u32 v17, v44, 10, v46
    s_lshl_b32 s56, s6, 1
    s_add_u32 s56, s56, s52
    s_lshl_b32 s47, s7, 8
    s_lshl_b32 s48, s58, 10
    s_add_u32 s48, s48, s47
    s_mul_i32 s90, s56, 229376
    s_add_u32 s90, s90, s48
    s_lshl_b32 s91, s56, 16
    s_add_u32 s91, s91, s48
    s_mul_i32 s96, s56, 14336
    s_add_u32 s96, s96, s53
    s_lshl_b32 s97, s56, 12
    s_add_u32 s97, s97, s53
    s_add_u32 s97, s97, 114688
    s_lshl_b32 s48, s4, 4
    s_add_u32 s48, s48, s56
    s_lshl_b32 s48, s48, 7
    s_and_b32 s44, s3, 2
    s_lshl_b32 s44, s44, 3
    s_add_u32 s44, s44, s48
    s_add_u32 s44, s44, 12582912
    s_mul_i32 s98, s7, 5
    s_lshr_b32 s98, s98, 1
    s_add_u32 s98, s98, s4
    s_and_b32 s98, s98, 7
    s_lshl_b32 s56, s56, 5
    s_add_u32 s7, s47, s56
    s_lshl_b32 s45, s4, 17
    s_lshl_b32 s48, s58, 13
    s_add_u32 s45, s45, s48
    s_add_u32 s45, s45, s7
    s_and_b32 s99, s3, 1
    s_lshl_b32 s99, s99, 1
    s_lshl_b32 s64, s52, 1
    s_lshl_b32 s49, s52, 13
    s_lshl_b32 s48, s58, 8
    s_add_u32 s49, s49, s48
    v_bfe_u32 v60, v1, 2, 2
    v_lshrrev_b32 v61, 5, v1
    v_lshl_add_u32 v60, v61, 2, v60
    v_lshlrev_b32 v60, 5, v60
    v_bfe_u32 v62, v1, 1, 1
    v_lshl_add_u32 v60, v62, 3, v60
    v_bfe_u32 v62, v1, 4, 1
    v_lshl_add_u32 v60, v62, 4, v60
    s_lshl_b32 s48, s52, 10
    s_add_u32 s48, s48, 161792
    v_add_u32 v10, s48, v60
    v_bfe_u32 v60, v1, 2, 1
    v_mul_u32_u24 v60, 0x8000, v60
    v_lshl_or_b32 v11, v60, 16, v60
    v_and_b32 v60, 31, v1
    v_lshlrev_b32 v60, 6, v60
    s_lshl_b32 s48, s58, 9
    v_bfe_u32 v62, v1, 1, 2
    v_lshlrev_b32 v63, 1, v61
    v_xor_b32 v63, v63, v62
    s_lshl_b32 s56, s52, 14
    s_add_u32 s56, s56, s48
    v_lshl_add_u32 v26, v63, 4, v60
    v_add_u32 v26, s56, v26
    v_xor_b32 v63, v61, v62
    s_lshl_b32 s56, s52, 13
    s_add_u32 s56, s56, s48
    s_add_u32 s56, s56, 32768
    v_lshl_add_u32 v18, v63, 4, v60
    v_add_u32 v18, s56, v18
    s_lshl_b32 s47, s5, 4
    s_add_u32 s47, s47, s4
    s_mul_i32 s47, s47, 4608
    s_mul_i32 s48, s3, 1152
    s_add_u32 s47, s47, s48
    s_add_u32 s47, s47, 10485760
    s_cmp_lt_u32 s3, 4
    s_cselect_b32 s62, s47, 0x7f000000
    s_lshl_b32 s47, s5, 2
    s_lshl_b32 s48, s52, 1
    s_add_u32 s47, s47, s48
    s_add_u32 s47, s47, 112
    s_lshl_b32 s47, s47, 10
    s_add_u32 s63, s47, s53
    s_waitcnt vmcnt(3)
    s_barrier
    ds_read_b128 v[128:131], v2 offset:0
    ds_read_b64_tr_b16 v[64:65], v6 offset:0
    ds_read_b64_tr_b16 v[66:67], v6 offset:512
    ds_read_b128 v[132:135], v3 offset:0
    ds_read_b64_tr_b16 v[68:69], v7 offset:0
    ds_read_b64_tr_b16 v[70:71], v7 offset:512
    s_setprio 1
    s_waitcnt lgkmcnt(3)
    v_mfma_f32_32x32x16_bf16 v[80:95], v[64:67], v[128:131], 0
    ds_read_b128 v[136:139], v4 offset:0
    ds_read_b64_tr_b16 v[72:73], v8 offset:0
    ds_read_b64_tr_b16 v[74:75], v8 offset:512
    v_mfma_f32_4x4x4_16b_bf16 v[52:55], v[128:129], v[128:129], 0
    v_mfma_f32_4x4x4_16b_bf16 v[60:63], v[130:131], v[130:131], 0
    v_mfma_f32_16x16x32_bf16 v[48:51], v[36:39], v[128:131], 0
    v_mfma_f32_16x16x32_bf16 v[40:43], v[36:39], v[64:67], 0
    s_add_u32 m0, s46, 32768
    s_mul_i32 s101, s65, 1536
    buffer_load_dwordx4 v14, s[8:11], s65 offen lds
    buffer_load_dwordx4 v15, s[8:11], s65 offen offset:1024 lds
    s_add_u32 m0, s100, 81920
    s_add_u32 s65, s65, 128
    buffer_load_dwordx4 v22, s[20:23], s101 offen lds
    s_and_b32 s65, s65, 1023
    s_setprio 0
    s_waitcnt lgkmcnt(3)
    v_mfma_f32_32x32x16_bf16 v[80:95], v[68:71], v[132:135], v[80:95]
    ds_read_b128 v[140:143], v5 offset:0
    ds_read_b64_tr_b16 v[76:77], v9 offset:0
    ds_read_b64_tr_b16 v[78:79], v9 offset:512
    s_waitcnt lgkmcnt(5)
    v_mfma_f32_4x4x4_16b_bf16 v[52:55], v[136:137], v[136:137], v[52:55]
    v_mfma_f32_4x4x4_16b_bf16 v[60:63], v[138:139], v[138:139], v[60:63]
    v_mfma_f32_16x16x32_bf16 v[48:51], v[36:39], v[136:139], v[48:51]
    s_waitcnt vmcnt(3)
    s_barrier
    s_setprio 3
    s_waitcnt lgkmcnt(3)
    v_mfma_f32_32x32x16_bf16 v[80:95], v[72:75], v[136:139], v[80:95]
    ds_read_b128 v[144:147], v2 offset:16384
    ds_read_b64_tr_b16 v[64:65], v6 offset:8192
    ds_read_b64_tr_b16 v[66:67], v6 offset:8704
    s_add_u32 m0, s46, 49152
    s_mul_i32 s101, s65, 1536
    buffer_load_dwordx4 v14, s[8:11], s65 offen lds
    s_lshl_b32 s47, s3, 8
    s_add_u32 s47, s47, s2
    s_sub_u32 s47, s47, 256
    s_cmp_lt_u32 s47, 8
    s_cbranch_scc0 L_nd
    s_lshl_b32 s47, s2, 2
    v_mov_b32 v13, 1
    buffer_store_dword v13, v12, s[28:31], s47 offen sc1
L_nd:
    s_setprio 2
    s_waitcnt lgkmcnt(3)
    v_mfma_f32_32x32x16_bf16 v[80:95], v[76:79], v[140:143], v[80:95]
    ds_read_b128 v[148:151], v3 offset:16384
    ds_read_b64_tr_b16 v[68:69], v7 offset:8192
    ds_read_b64_tr_b16 v[70:71], v7 offset:8704
    s_waitcnt lgkmcnt(5)
    v_mfma_f32_4x4x4_16b_bf16 v[52:55], v[144:145], v[144:145], v[52:55]
    v_mfma_f32_4x4x4_16b_bf16 v[60:63], v[146:147], v[146:147], v[60:63]
    v_mfma_f32_16x16x32_bf16 v[48:51], v[36:39], v[144:147], v[48:51]
    buffer_load_dwordx4 v15, s[8:11], s65 offen offset:1024 lds
    s_setprio 1
    s_waitcnt lgkmcnt(3)
    v_mfma_f32_32x32x16_bf16 v[80:95], v[64:67], v[144:147], v[80:95]
    ds_read_b128 v[152:155], v4 offset:16384
    ds_read_b64_tr_b16 v[72:73], v8 offset:8192
    ds_read_b64_tr_b16 v[74:75], v8 offset:8704
    v_mfma_f32_16x16x32_bf16 v[40:43], v[36:39], v[64:67], v[40:43]
    s_add_u32 m0, s100, 90112
    s_add_u32 s65, s65, 128
    buffer_load_dwordx4 v22, s[20:23], s101 offen lds
    s_and_b32 s65, s65, 1023
    s_setprio 0
    s_waitcnt lgkmcnt(3)
    v_mfma_f32_32x32x16_bf16 v[80:95], v[68:71], v[148:151], v[80:95]
    ds_read_b128 v[156:159], v5 offset:16384
    ds_read_b64_tr_b16 v[76:77], v9 offset:8192
    ds_read_b64_tr_b16 v[78:79], v9 offset:8704
    s_waitcnt lgkmcnt(5)
    v_mfma_f32_4x4x4_16b_bf16 v[52:55], v[152:153], v[152:153], v[52:55]
    v_mfma_f32_4x4x4_16b_bf16 v[60:63], v[154:155], v[154:155], v[60:63]
    v_mfma_f32_16x16x32_bf16 v[48:51], v[36:39], v[152:155], v[48:51]
    v_mul_u32_u24 v45, 3072, v1
    buffer_load_dword v46, v45, s[20:23], s57 offen
    s_waitcnt vmcnt(4)
    s_barrier
    s_setprio 3
    s_waitcnt lgkmcnt(3)
    v_mfma_f32_32x32x16_bf16 v[80:95], v[72:75], v[152:155], v[80:95]
    ds_read_b128 v[160:163], v2 offset:32768
    ds_read_b64_tr_b16 v[64:65], v6 offset:16384
    ds_read_b64_tr_b16 v[66:67], v6 offset:16896
    s_add_u32 m0, s46, 0
    s_mul_i32 s101, s65, 1536
    buffer_load_dwordx4 v14, s[8:11], s65 offen lds
    s_setprio 2
    s_waitcnt lgkmcnt(3)
    v_mfma_f32_32x32x16_bf16 v[80:95], v[76:79], v[156:159], v[80:95]
    ds_read_b128 v[164:167], v3 offset:32768
    ds_read_b64_tr_b16 v[68:69], v7 offset:16384
    ds_read_b64_tr_b16 v[70:71], v7 offset:16896
    s_waitcnt lgkmcnt(5)
    v_mfma_f32_4x4x4_16b_bf16 v[52:55], v[160:161], v[160:161], v[52:55]
    v_mfma_f32_4x4x4_16b_bf16 v[60:63], v[162:163], v[162:163], v[60:63]
    v_mfma_f32_16x16x32_bf16 v[48:51], v[36:39], v[160:163], v[48:51]
    buffer_load_dwordx4 v15, s[8:11], s65 offen offset:1024 lds
    s_setprio 1
    s_waitcnt lgkmcnt(3)
    v_mfma_f32_32x32x16_bf16 v[80:95], v[64:67], v[160:163], v[80:95]
    ds_read_b128 v[168:171], v4 offset:32768
    ds_read_b64_tr_b16 v[72:73], v8 offset:16384
    ds_read_b64_tr_b16 v[74:75], v8 offset:16896
    v_mfma_f32_16x16x32_bf16 v[40:43], v[36:39], v[64:67], v[40:43]
    s_add_u32 m0, s100, 98304
    s_add_u32 s65, s65, 128
    buffer_load_dwordx4 v22, s[20:23], s101 offen lds
    s_and_b32 s65, s65, 1023
    s_setprio 0
    s_waitcnt lgkmcnt(3)
    v_mfma_f32_32x32x16_bf16 v[80:95], v[68:71], v[164:167], v[80:95]
    ds_read_b128 v[172:175], v5 offset:32768
    ds_read_b64_tr_b16 v[76:77], v9 offset:16384
    ds_read_b64_tr_b16 v[78:79], v9 offset:16896
    s_waitcnt lgkmcnt(5)
    v_mfma_f32_4x4x4_16b_bf16 v[52:55], v[168:169], v[168:169], v[52:55]
    v_mfma_f32_4x4x4_16b_bf16 v[60:63], v[170:171], v[170:171], v[60:63]
    v_mfma_f32_16x16x32_bf16 v[48:51], v[36:39], v[168:171], v[48:51]
    s_waitcnt vmcnt(4)
    s_barrier
    s_setprio 3
    s_waitcnt lgkmcnt(3)
    v_mfma_f32_32x32x16_bf16 v[80:95], v[72:75], v[168:171], v[80:95]
    ds_read_b128 v[176:179], v2 offset:49152
    ds_read_b64_tr_b16 v[64:65], v6 offset:24576
    ds_read_b64_tr_b16 v[66:67], v6 offset:25088
    s_add_u32 m0, s46, 16384
    s_mul_i32 s101, s65, 1536
    buffer_load_dwordx4 v14, s[8:11], s65 offen lds
    s_setprio 2
    s_waitcnt lgkmcnt(3)
    v_mfma_f32_32x32x16_bf16 v[80:95], v[76:79], v[172:175], v[80:95]
    ds_read_b128 v[180:183], v3 offset:49152
    ds_read_b64_tr_b16 v[68:69], v7 offset:24576
    ds_read_b64_tr_b16 v[70:71], v7 offset:25088
    s_waitcnt lgkmcnt(5)
    v_mfma_f32_4x4x4_16b_bf16 v[52:55], v[176:177], v[176:177], v[52:55]
    v_mfma_f32_4x4x4_16b_bf16 v[60:63], v[178:179], v[178:179], v[60:63]
    v_mfma_f32_16x16x32_bf16 v[48:51], v[36:39], v[176:179], v[48:51]
    buffer_load_dwordx4 v15, s[8:11], s65 offen offset:1024 lds
    s_setprio 1
    s_waitcnt lgkmcnt(3)
    v_mfma_f32_32x32x16_bf16 v[80:95], v[64:67], v[176:179], v[80:95]
    ds_read_b128 v[184:187], v4 offset:49152
    ds_read_b64_tr_b16 v[72:73], v8 offset:24576
    ds_read_b64_tr_b16 v[74:75], v8 offset:25088
    v_mfma_f32_16x16x32_bf16 v[40:43], v[36:39], v[64:67], v[40:43]
    s_add_u32 m0, s100, 106496
    s_add_u32 s65, s65, 128
    buffer_load_dwordx4 v22, s[20:23], s101 offen lds
    s_and_b32 s65, s65, 1023
    s_setprio 0
    s_waitcnt lgkmcnt(3)
    v_mfma_f32_32x32x16_bf16 v[80:95], v[68:71], v[180:183], v[80:95]
    ds_read_b128 v[188:191], v5 offset:49152
    ds_read_b64_tr_b16 v[76:77], v9 offset:24576
    ds_read_b64_tr_b16 v[78:79], v9 offset:25088
    s_waitcnt lgkmcnt(5)
    v_mfma_f32_4x4x4_16b_bf16 v[52:55], v[184:185], v[184:185], v[52:55]
    v_mfma_f32_4x4x4_16b_bf16 v[60:63], v[186:187], v[186:187], v[60:63]
    v_mfma_f32_16x16x32_bf16 v[48:51], v[36:39], v[184:187], v[48:51]
    s_waitcnt vmcnt(3)
    s_barrier
    s_setprio 3
    s_waitcnt lgkmcnt(3)
    v_mfma_f32_32x32x16_bf16 v[80:95], v[72:75], v[184:187], v[80:95]
    ds_read_b128 v[192:195], v2 offset:0
    ds_read_b64_tr_b16 v[64:65], v6 offset:32768
    ds_read_b64_tr_b16 v[66:67], v6 offset:33280
    s_add_u32 m0, s46, 32768
    s_mul_i32 s101, s65, 1536
    buffer_load_dwordx4 v14, s[8:11], s65 offen lds
    s_setprio 2
    s_waitcnt lgkmcnt(3)
    v_mfma_f32_32x32x16_bf16 v[80:95], v[76:79], v[188:191], v[80:95]
    ds_read_b128 v[196:199], v3 offset:0
    ds_read_b64_tr_b16 v[68:69], v7 offset:32768
    ds_read_b64_tr_b16 v[70:71], v7 offset:33280
    s_waitcnt lgkmcnt(5)
    v_mfma_f32_4x4x4_16b_bf16 v[52:55], v[192:193], v[192:193], v[52:55]
    v_mfma_f32_4x4x4_16b_bf16 v[60:63], v[194:195], v[194:195], v[60:63]
    v_mfma_f32_16x16x32_bf16 v[48:51], v[36:39], v[192:195], v[48:51]
    buffer_load_dwordx4 v15, s[8:11], s65 offen offset:1024 lds
    s_setprio 1
    s_waitcnt lgkmcnt(3)
    v_mfma_f32_32x32x16_bf16 v[80:95], v[64:67], v[192:195], v[80:95]
    ds_read_b128 v[200:203], v4 offset:0
    ds_read_b64_tr_b16 v[72:73], v8 offset:32768
    ds_read_b64_tr_b16 v[74:75], v8 offset:33280
    v_mfma_f32_16x16x32_bf16 v[40:43], v[36:39], v[64:67], v[40:43]
    s_add_u32 m0, s100, 114688
    s_add_u32 s65, s65, 128
    buffer_load_dwordx4 v22, s[20:23], s101 offen lds
    s_and_b32 s65, s65, 1023
    s_setprio 0
    s_waitcnt lgkmcnt(3)
    v_mfma_f32_32x32x16_bf16 v[80:95], v[68:71], v[196:199], v[80:95]
    ds_read_b128 v[204:207], v5 offset:0
    ds_read_b64_tr_b16 v[76:77], v9 offset:32768
    ds_read_b64_tr_b16 v[78:79], v9 offset:33280
    s_waitcnt lgkmcnt(5)
    v_mfma_f32_4x4x4_16b_bf16 v[52:55], v[200:201], v[200:201], v[52:55]
    v_mfma_f32_4x4x4_16b_bf16 v[60:63], v[202:203], v[202:203], v[60:63]
    v_mfma_f32_16x16x32_bf16 v[48:51], v[36:39], v[200:203], v[48:51]
    s_waitcnt vmcnt(3)
    s_barrier
    s_setprio 3
    s_waitcnt lgkmcnt(3)
    v_mfma_f32_32x32x16_bf16 v[80:95], v[72:75], v[200:203], v[80:95]
    ds_read_b128 v[208:211], v2 offset:16384
    ds_read_b64_tr_b16 v[64:65], v6 offset:40960
    ds_read_b64_tr_b16 v[66:67], v6 offset:41472
    s_add_u32 m0, s46, 49152
    s_mul_i32 s101, s65, 1536
    buffer_load_dwordx4 v14, s[8:11], s65 offen lds
    s_setprio 2
    s_waitcnt lgkmcnt(3)
    v_mfma_f32_32x32x16_bf16 v[80:95], v[76:79], v[204:207], v[80:95]
    ds_read_b128 v[212:215], v3 offset:16384
    ds_read_b64_tr_b16 v[68:69], v7 offset:40960
    ds_read_b64_tr_b16 v[70:71], v7 offset:41472
    s_waitcnt lgkmcnt(5)
    v_mfma_f32_4x4x4_16b_bf16 v[52:55], v[208:209], v[208:209], v[52:55]
    v_mfma_f32_4x4x4_16b_bf16 v[60:63], v[210:211], v[210:211], v[60:63]
    v_mfma_f32_16x16x32_bf16 v[48:51], v[36:39], v[208:211], v[48:51]
    buffer_load_dwordx4 v15, s[8:11], s65 offen offset:1024 lds
    s_setprio 1
    s_waitcnt lgkmcnt(3)
    v_mfma_f32_32x32x16_bf16 v[80:95], v[64:67], v[208:211], v[80:95]
    ds_read_b128 v[216:219], v4 offset:16384
    ds_read_b64_tr_b16 v[72:73], v8 offset:40960
    ds_read_b64_tr_b16 v[74:75], v8 offset:41472
    v_mfma_f32_16x16x32_bf16 v[40:43], v[36:39], v[64:67], v[40:43]
    s_add_u32 m0, s100, 122880
    s_add_u32 s65, s65, 128
    buffer_load_dwordx4 v22, s[20:23], s101 offen lds
    s_and_b32 s65, s65, 1023
    s_setprio 0
    s_waitcnt lgkmcnt(3)
    v_mfma_f32_32x32x16_bf16 v[80:95], v[68:71], v[212:215], v[80:95]
    ds_read_b128 v[220:223], v5 offset:16384
    ds_read_b64_tr_b16 v[76:77], v9 offset:40960
    ds_read_b64_tr_b16 v[78:79], v9 offset:41472
    s_waitcnt lgkmcnt(5)
    v_mfma_f32_4x4x4_16b_bf16 v[52:55], v[216:217], v[216:217], v[52:55]
    v_mfma_f32_4x4x4_16b_bf16 v[60:63], v[218:219], v[218:219], v[60:63]
    v_mfma_f32_16x16x32_bf16 v[48:51], v[36:39], v[216:219], v[48:51]
    s_waitcnt vmcnt(3)
    s_barrier
    s_setprio 3
    s_waitcnt lgkmcnt(3)
    v_mfma_f32_32x32x16_bf16 v[80:95], v[72:75], v[216:219], v[80:95]
    ds_read_b128 v[224:227], v2 offset:32768
    ds_read_b64_tr_b16 v[64:65], v6 offset:49152
    ds_read_b64_tr_b16 v[66:67], v6 offset:49664
    s_add_u32 m0, s46, 0
    s_add_u32 s101, s32, 2048
    buffer_load_dwordx4 v16, s[20:23], s101 offen lds
    s_setprio 2
    s_waitcnt lgkmcnt(3)
    v_mfma_f32_32x32x16_bf16 v[80:95], v[76:79], v[220:223], v[80:95]
    ds_read_b128 v[228:231], v3 offset:32768
    ds_read_b64_tr_b16 v[68:69], v7 offset:49152
    ds_read_b64_tr_b16 v[70:71], v7 offset:49664
    s_waitcnt lgkmcnt(5)
    v_mfma_f32_4x4x4_16b_bf16 v[52:55], v[224:225], v[224:225], v[52:55]
    v_mfma_f32_4x4x4_16b_bf16 v[60:63], v[226:227], v[226:227], v[60:63]
    v_mfma_f32_16x16x32_bf16 v[48:51], v[36:39], v[224:227], v[48:51]
    s_add_u32 s101, s101, 23552
    buffer_load_dwordx4 v16, s[20:23], s101 offen offset:1024 lds
    s_setprio 1
    s_waitcnt lgkmcnt(3)
    v_mfma_f32_32x32x16_bf16 v[80:95], v[64:67], v[224:227], v[80:95]
    ds_read_b128 v[232:235], v4 offset:32768
    ds_read_b64_tr_b16 v[72:73], v8 offset:49152
    ds_read_b64_tr_b16 v[74:75], v8 offset:49664
    v_mfma_f32_16x16x32_bf16 v[40:43], v[36:39], v[64:67], v[40:43]
    s_setprio 0
    s_waitcnt lgkmcnt(3)
    v_mfma_f32_32x32x16_bf16 v[80:95], v[68:71], v[228:231], v[80:95]
    ds_read_b128 v[236:239], v5 offset:32768
    ds_read_b64_tr_b16 v[76:77], v9 offset:49152
    ds_read_b64_tr_b16 v[78:79], v9 offset:49664
    s_waitcnt lgkmcnt(5)
    v_mfma_f32_4x4x4_16b_bf16 v[52:55], v[232:233], v[232:233], v[52:55]
    v_mfma_f32_4x4x4_16b_bf16 v[60:63], v[234:235], v[234:235], v[60:63]
    v_mfma_f32_16x16x32_bf16 v[48:51], v[36:39], v[232:235], v[48:51]
    s_waitcnt vmcnt(2)
    s_barrier
    s_setprio 3
    s_waitcnt lgkmcnt(3)
    v_mfma_f32_32x32x16_bf16 v[80:95], v[72:75], v[232:235], v[80:95]
    ds_read_b128 v[240:243], v2 offset:49152
    ds_read_b64_tr_b16 v[64:65], v6 offset:57344
    ds_read_b64_tr_b16 v[66:67], v6 offset:57856
    s_add_u32 m0, s46, 16384
    s_add_u32 s101, s33, 2048
    buffer_load_dwordx4 v16, s[20:23], s101 offen lds
    s_setprio 2
    s_waitcnt lgkmcnt(3)
    v_mfma_f32_32x32x16_bf16 v[80:95], v[76:79], v[236:239], v[80:95]
    ds_read_b128 v[244:247], v3 offset:49152
    ds_read_b64_tr_b16 v[68:69], v7 offset:57344
    ds_read_b64_tr_b16 v[70:71], v7 offset:57856
    s_waitcnt lgkmcnt(5)
    v_mfma_f32_4x4x4_16b_bf16 v[52:55], v[240:241], v[240:241], v[52:55]
    v_mfma_f32_4x4x4_16b_bf16 v[60:63], v[242:243], v[242:243], v[60:63]
    v_mfma_f32_16x16x32_bf16 v[48:51], v[36:39], v[240:243], v[48:51]
    s_add_u32 s101, s101, 23552
    buffer_load_dwordx4 v16, s[20:23], s101 offen offset:1024 lds
    s_setprio 1
    s_waitcnt lgkmcnt(3)
    v_mfma_f32_32x32x16_bf16 v[80:95], v[64:67], v[240:243], v[80:95]
    ds_read_b128 v[248:251], v4 offset:49152
    ds_read_b64_tr_b16 v[72:73], v8 offset:57344
    ds_read_b64_tr_b16 v[74:75], v8 offset:57856
    v_and_b32 v20, 3, v1
    v_cmp_eq_u32 s[60:61], 1, v20
    s_lshl_b32 s47, s52, 3
    v_add_u32 v44, s47, v19
    v_mfma_f32_16x16x32_bf16 v[40:43], v[36:39], v[64:67], v[40:43]
    s_setprio 0
    s_waitcnt lgkmcnt(3)
    v_mfma_f32_32x32x16_bf16 v[80:95], v[68:71], v[244:247], v[80:95]
    ds_read_b128 v[252:255], v5 offset:49152
    ds_read_b64_tr_b16 v[76:77], v9 offset:57344
    ds_read_b64_tr_b16 v[78:79], v9 offset:57856
    s_waitcnt lgkmcnt(5)
    v_mfma_f32_4x4x4_16b_bf16 v[52:55], v[248:249], v[248:249], v[52:55]
    v_mfma_f32_4x4x4_16b_bf16 v[60:63], v[250:251], v[250:251], v[60:63]
    v_mfma_f32_16x16x32_bf16 v[48:51], v[36:39], v[248:251], v[48:51]
    s_nop 3
    v_add_f32 v52, v52, v60
    v_add_f32 v53, v53, v61
    v_add_f32 v54, v54, v62
    v_add_f32 v55, v55, v63
    v_cmp_eq_u32 vcc, 2, v20
    v_cndmask_b32 v21, v52, v53, s[60:61]
    v_cmp_eq_u32 s[60:61], 3, v20
    v_cndmask_b32 v21, v21, v54, vcc
    s_nop 0
    v_cndmask_b32 v21, v21, v55, s[60:61]
    v_mov_b32 v20, v21
    s_nop 1
    v_permlane32_swap_b32 v20, v21
    v_add_f32 v49, v20, v21
    ds_write_b64 v44, v[48:49]
    v_add_u32 v41, s58, v0
    ds_write_b32 v41, v40 offset:0
    s_waitcnt vmcnt(2) lgkmcnt(0)
    s_barrier
    s_setprio 3
    v_mfma_f32_32x32x16_bf16 v[80:95], v[72:75], v[248:251], v[80:95]
    v_xor_b32 v6, 65536, v6
    ds_read_b64_tr_b16 v[64:65], v6 offset:0
    ds_read_b64_tr_b16 v[66:67], v6 offset:512
    ds_read_b128 v[48:51], v19
    ds_read_b128 v[56:59], v0
    s_add_u32 m0, s46, 32768
    s_add_u32 s101, s34, 2048
    buffer_load_dwordx4 v16, s[20:23], s101 offen lds
    s_setprio 2
    v_mfma_f32_32x32x16_bf16 v[80:95], v[76:79], v[252:255], v[80:95]
    v_xor_b32 v7, 65536, v7
    ds_read_b64_tr_b16 v[68:69], v7 offset:0
    ds_read_b64_tr_b16 v[70:71], v7 offset:512
    s_add_u32 s101, s101, 23552
    buffer_load_dwordx4 v16, s[20:23], s101 offen offset:1024 lds
    s_setprio 3
    s_waitcnt lgkmcnt(4)
    v_mfma_f32_32x32x16_bf16 v[96:111], v[64:67], v[128:131], 0
    v_xor_b32 v8, 65536, v8
    ds_read_b64_tr_b16 v[72:73], v8 offset:0
    ds_read_b64_tr_b16 v[74:75], v8 offset:512
    v_mfma_f32_16x16x32_bf16 v[40:43], v[36:39], v[64:67], 0
    s_waitcnt lgkmcnt(5)
    v_add_f32 v20, v48, v50
    v_add_f32 v21, v49, v51
    v_mul_f32 v20, 0xbb000000, v20
    v_mul_f32 v60, v20, v20
    v_fma_f32 v21, v21, s59, -v60
    v_max_f32 v21, 0, v21
    s_add_u32 m0, s46, 49152
    s_add_u32 s101, s35, 2048
    buffer_load_dwordx4 v16, s[20:23], s101 offen lds
    s_waitcnt lgkmcnt(2)
    v_mfma_f32_32x32x16_bf16 v[96:111], v[68:71], v[132:135], v[96:111]
    v_xor_b32 v9, 65536, v9
    ds_read_b64_tr_b16 v[76:77], v9 offset:0
    ds_read_b64_tr_b16 v[78:79], v9 offset:512
    v_cvt_pk_bf16_f32 v60, v21, v20
    v_lshlrev_b32 v21, 16, v60
    v_add_f32 v21, 0x3727c5ac, v21
    v_cvt_pk_bf16_f32 v21, v21, v21
    v_and_b32 v21, 0xffff0000, v21
    v_sqrt_f32 v21, v21
    s_add_u32 s101, s101, 23552
    buffer_load_dwordx4 v16, s[20:23], s101 offen offset:1024 lds
    s_setprio 2
    s_waitcnt lgkmcnt(2)
    v_mfma_f32_32x32x16_bf16 v[96:111], v[72:75], v[136:139], v[96:111]
    ds_read_b64_tr_b16 v[64:65], v6 offset:8192
    ds_read_b64_tr_b16 v[66:67], v6 offset:8704
    v_lshrrev_b32 v28, 16, v60
    v_cmp_gt_u32 vcc, 32, v1
    v_cvt_pk_bf16_f32 v29, v20, v21
    v_mov_b32 v30, 0
    v_and_b32 v24, 0xffff0000, v29
    v_rcp_f32 v23, v24
    v_cndmask_b32 v28, 0, v28, vcc
    s_waitcnt lgkmcnt(2)
    v_mfma_f32_32x32x16_bf16 v[96:111], v[76:79], v[140:143], v[96:111]
    ds_read_b64_tr_b16 v[68:69], v7 offset:8192
    ds_read_b64_tr_b16 v[70:71], v7 offset:8704
    v_cndmask_b32 v29, 0, v29, vcc
    v_add_f32 v22, v56, v57
    v_add_f32 v58, v58, v59
    v_add_f32 v22, v22, v58
    v_cvt_pk_bf16_f32 v32, v22, v22
    v_and_b32 v62, 0xffff0000, v32
    s_add_u32 m0, s46, 65536
    s_add_u32 s101, s32, 0
    buffer_load_dwordx4 v16, s[20:23], s101 offen lds
    s_setprio 1
    s_waitcnt lgkmcnt(2)
    v_mfma_f32_32x32x16_bf16 v[96:111], v[64:67], v[144:147], v[96:111]
    ds_read_b64_tr_b16 v[72:73], v8 offset:8192
    ds_read_b64_tr_b16 v[74:75], v8 offset:8704
    v_mfma_f32_16x16x32_bf16 v[40:43], v[36:39], v[64:67], v[40:43]
    v_sub_f32 v62, v22, v62
    v_cvt_pk_bf16_f32 v33, v62, 0
    s_nop 1
    v_mfma_f32_32x32x16_bf16 v[80:95], v[32:35], v[28:31], v[80:95]
    ds_read_b64_tr_b16 v[2:3], v10 offset:0
    ds_read_b64_tr_b16 v[4:5], v10 offset:256
    s_waitcnt lgkmcnt(1)
    v_xor_b32 v2, v11, v2
    v_mfma_f32_32x32x16_bf16 v[96:111], v[68:71], v[148:151], v[96:111]
    ds_read_b64_tr_b16 v[76:77], v9 offset:8192
    ds_read_b64_tr_b16 v[78:79], v9 offset:8704
    v_xor_b32 v3, v11, v3
    s_waitcnt lgkmcnt(2)
    v_xor_b32 v4, v11, v4
    v_xor_b32 v5, v11, v5
    ds_read_b64_tr_b16 v[52:53], v10 offset:512
    ds_read_b64_tr_b16 v[54:55], v10 offset:768
    s_waitcnt lgkmcnt(1)
    v_xor_b32 v52, v11, v52
    v_xor_b32 v53, v11, v53
    s_add_u32 s101, s101, 23552
    buffer_load_dwordx4 v16, s[20:23], s101 offen offset:1024 lds
    s_setprio 0
    v_mfma_f32_32x32x16_bf16 v[96:111], v[72:75], v[152:155], v[96:111]
    s_waitcnt vmcnt(2)
    s_barrier
    ds_read_b64_tr_b16 v[64:65], v6 offset:16384
    ds_read_b64_tr_b16 v[66:67], v6 offset:16896
    s_waitcnt lgkmcnt(2)
    v_xor_b32 v54, v11, v54
    v_xor_b32 v55, v11, v55
    v_mul_f32 v25, 0x3fb8aa3b, v23
    v_cvt_pk_bf16_f32 v44, v80, v81
    v_cvt_pk_bf16_f32 v45, v82, v83
    v_cvt_pk_bf16_f32 v46, v84, v85
    s_add_u32 m0, s46, 81920
    s_add_u32 s101, s33, 0
    buffer_load_dwordx4 v16, s[20:23], s101 offen lds
    s_cmp_eq_u32 s3, 7
    s_cbranch_scc0 L_npa
    v_and_b32 v14, 28, v1
    buffer_load_dword v14, v14, s[28:31], 0 offen sc1
L_npa:
    v_mfma_f32_32x32x16_bf16 v[96:111], v[76:79], v[156:159], v[96:111]
    ds_read_b64_tr_b16 v[68:69], v7 offset:16384
    ds_read_b64_tr_b16 v[70:71], v7 offset:16896
    v_cvt_pk_bf16_f32 v47, v86, v87
    v_cvt_pk_bf16_f32 v48, v88, v89
    v_cvt_pk_bf16_f32 v49, v90, v91
    v_cvt_pk_bf16_f32 v50, v92, v93
    v_cvt_pk_bf16_f32 v51, v94, v95
    v_mfma_f32_32x32x16_bf16 v[112:127], v[2:5], v[44:47], 0
    s_nop 0
    v_mfma_f32_32x32x16_bf16 v[80:95], v[52:55], v[48:51], 0
    s_setprio 3
    s_waitcnt lgkmcnt(2)
    v_mfma_f32_32x32x16_bf16 v[96:111], v[64:67], v[160:163], v[96:111]
    ds_read_b64_tr_b16 v[72:73], v8 offset:16384
    ds_read_b64_tr_b16 v[74:75], v8 offset:16896
    v_mfma_f32_16x16x32_bf16 v[40:43], v[36:39], v[64:67], v[40:43]
    s_add_u32 s101, s101, 23552
    buffer_load_dwordx4 v16, s[20:23], s101 offen offset:1024 lds
    s_waitcnt lgkmcnt(2)
    v_mfma_f32_32x32x16_bf16 v[96:111], v[68:71], v[164:167], v[96:111]
    ds_read_b64_tr_b16 v[76:77], v9 offset:16384
    ds_read_b64_tr_b16 v[78:79], v9 offset:16896
    v_max3_f32 v60, v112, v113, v114
    v_max3_f32 v61, v115, v116, v117
    v_max3_f32 v60, v60, v118, v119
    v_max3_f32 v61, v61, v120, v121
    v_max3_f32 v60, v60, v122, v123
    v_max3_f32 v61, v61, v124, v125
    v_max3_f32 v60, v60, v126, v127
    s_add_u32 m0, s46, 98304
    s_add_u32 s101, s34, 0
    buffer_load_dwordx4 v16, s[20:23], s101 offen lds
    s_setprio 2
    s_waitcnt lgkmcnt(2)
    v_mfma_f32_32x32x16_bf16 v[96:111], v[72:75], v[168:171], v[96:111]
    ds_read_b64_tr_b16 v[64:65], v6 offset:24576
    ds_read_b64_tr_b16 v[66:67], v6 offset:25088
    v_max_f32 v60, v60, v61
    v_mul_f32 v60, v60, v25
    v_fma_f32 v112, v112, v25, -v60
    v_fma_f32 v113, v113, v25, -v60
    v_fma_f32 v114, v114, v25, -v60
    v_fma_f32 v115, v115, v25, -v60
    v_fma_f32 v116, v116, v25, -v60
    s_waitcnt lgkmcnt(2)
    v_mfma_f32_32x32x16_bf16 v[96:111], v[76:79], v[172:175], v[96:111]
    ds_read_b64_tr_b16 v[68:69], v7 offset:24576
    ds_read_b64_tr_b16 v[70:71], v7 offset:25088
    v_fma_f32 v117, v117, v25, -v60
    v_fma_f32 v118, v118, v25, -v60
    v_fma_f32 v119, v119, v25, -v60
    v_fma_f32 v120, v120, v25, -v60
    v_fma_f32 v121, v121, v25, -v60
    v_fma_f32 v122, v122, v25, -v60
    v_fma_f32 v123, v123, v25, -v60
    s_add_u32 s101, s101, 23552
    buffer_load_dwordx4 v16, s[20:23], s101 offen offset:1024 lds
    s_setprio 1
    s_waitcnt lgkmcnt(2)
    v_mfma_f32_32x32x16_bf16 v[96:111], v[64:67], v[176:179], v[96:111]
    ds_read_b64_tr_b16 v[72:73], v8 offset:24576
    ds_read_b64_tr_b16 v[74:75], v8 offset:25088
    v_mfma_f32_16x16x32_bf16 v[40:43], v[36:39], v[64:67], v[40:43]
    v_fma_f32 v124, v124, v25, -v60
    v_fma_f32 v125, v125, v25, -v60
    v_fma_f32 v126, v126, v25, -v60
    v_fma_f32 v127, v127, v25, -v60
    v_exp_f32 v112, v112
    v_exp_f32 v113, v113
    v_exp_f32 v114, v114
    s_add_u32 m0, s46, 114688
    s_add_u32 s101, s35, 0
    buffer_load_dwordx4 v16, s[20:23], s101 offen lds
    s_waitcnt lgkmcnt(2)
    v_mfma_f32_32x32x16_bf16 v[96:111], v[68:71], v[180:183], v[96:111]
    ds_read_b64_tr_b16 v[76:77], v9 offset:24576
    ds_read_b64_tr_b16 v[78:79], v9 offset:25088
    v_exp_f32 v115, v115
    v_exp_f32 v116, v116
    v_exp_f32 v117, v117
    v_exp_f32 v118, v118
    v_exp_f32 v119, v119
    v_exp_f32 v120, v120
    v_exp_f32 v121, v121
    s_setprio 0
    s_waitcnt lgkmcnt(2)
    v_mfma_f32_32x32x16_bf16 v[96:111], v[72:75], v[184:187], v[96:111]
    ds_read_b64_tr_b16 v[64:65], v6 offset:32768
    ds_read_b64_tr_b16 v[66:67], v6 offset:33280
    v_mov_b32 v32, -1
    v_mov_b32 v33, -1
    v_mov_b32 v34, -1
    v_mov_b32 v35, -1
    v_lshrrev_b32 v21, 2, v1
    v_lshl_add_u32 v21, v21, 26, v27
    v_exp_f32 v122, v122
    v_exp_f32 v123, v123
    v_exp_f32 v124, v124
    v_exp_f32 v125, v125
    v_exp_f32 v126, v126
    v_exp_f32 v127, v127
    v_add_f32 v60, v112, v113
    s_add_u32 s101, s101, 23552
    buffer_load_dwordx4 v16, s[20:23], s101 offen offset:1024 lds
    s_waitcnt lgkmcnt(2)
    v_mfma_f32_32x32x16_bf16 v[96:111], v[76:79], v[188:191], v[96:111]
    ds_read_b64_tr_b16 v[68:69], v7 offset:32768
    ds_read_b64_tr_b16 v[70:71], v7 offset:33280
    buffer_store_dwordx4 v[32:35], v27, s[16:19], s62 offen sc1
    v_add_f32 v61, v114, v115
    v_add_f32 v60, v60, v116
    v_add_f32 v61, v61, v117
    v_add_f32 v60, v60, v118
    v_add_f32 v61, v61, v119
    v_add_f32 v60, v60, v120
    v_add_f32 v61, v61, v121
    s_setprio 3
    s_waitcnt lgkmcnt(2)
    v_mfma_f32_32x32x16_bf16 v[96:111], v[64:67], v[192:195], v[96:111]
    ds_read_b64_tr_b16 v[72:73], v8 offset:32768
    ds_read_b64_tr_b16 v[74:75], v8 offset:33280
    v_mfma_f32_16x16x32_bf16 v[40:43], v[36:39], v[64:67], v[40:43]
    buffer_store_dwordx4 v[32:35], v21, s[16:19], s62 offen offset:1024 sc1
    v_add_f32 v60, v60, v122
    v_add_f32 v61, v61, v123
    v_add_f32 v60, v60, v124
    v_add_f32 v61, v61, v125
    v_add_f32 v60, v60, v126
    v_add_f32 v61, v61, v127
    v_add_f32 v60, v60, v61
    s_waitcnt lgkmcnt(2)
    v_mfma_f32_32x32x16_bf16 v[96:111], v[68:71], v[196:199], v[96:111]
    ds_read_b64_tr_b16 v[76:77], v9 offset:32768
    ds_read_b64_tr_b16 v[78:79], v9 offset:33280
    v_rcp_f32 v60, v60
    s_nop 0
    v_mul_f32 v112, v112, v60
    v_mul_f32 v113, v113, v60
    v_mul_f32 v114, v114, v60
    v_mul_f32 v115, v115, v60
    v_mul_f32 v116, v116, v60
    v_mul_f32 v117, v117, v60
    s_setprio 2
    s_waitcnt lgkmcnt(2)
    v_mfma_f32_32x32x16_bf16 v[96:111], v[72:75], v[200:203], v[96:111]
    ds_read_b64_tr_b16 v[64:65], v6 offset:40960
    ds_read_b64_tr_b16 v[66:67], v6 offset:41472
    buffer_store_dwordx4 v[32:35], v27, s[16:19], s63 offen offset:0 sc1
    v_mul_f32 v118, v118, v60
    v_mul_f32 v119, v119, v60
    v_mul_f32 v120, v120, v60
    v_mul_f32 v121, v121, v60
    v_mul_f32 v122, v122, v60
    v_mul_f32 v123, v123, v60
    v_mul_f32 v124, v124, v60
    s_waitcnt lgkmcnt(2)
    v_mfma_f32_32x32x16_bf16 v[96:111], v[76:79], v[204:207], v[96:111]
    ds_read_b64_tr_b16 v[68:69], v7 offset:40960
    ds_read_b64_tr_b16 v[70:71], v7 offset:41472
    v_mul_f32 v125, v125, v60
    v_mul_f32 v126, v126, v60
    v_mul_f32 v127, v127, v60
    v_cvt_pk_bf16_f32 v52, v112, v113
    v_cvt_pk_bf16_f32 v53, v114, v115
    v_cvt_pk_bf16_f32 v54, v116, v117
    v_cvt_pk_bf16_f32 v55, v118, v119
    s_setprio 1
    s_waitcnt lgkmcnt(2)
    v_mfma_f32_32x32x16_bf16 v[96:111], v[64:67], v[208:211], v[96:111]
    ds_read_b64_tr_b16 v[72:73], v8 offset:40960
    ds_read_b64_tr_b16 v[74:75], v8 offset:41472
    v_mfma_f32_16x16x32_bf16 v[40:43], v[36:39], v[64:67], v[40:43]
    v_cvt_pk_bf16_f32 v56, v120, v121
    v_cvt_pk_bf16_f32 v57, v122, v123
    v_cvt_pk_bf16_f32 v58, v124, v125
    v_cvt_pk_bf16_f32 v59, v126, v127
    v_max3_f32 v60, v80, v81, v82
    v_max3_f32 v61, v83, v84, v85
    v_max3_f32 v60, v60, v86, v87
    s_waitcnt lgkmcnt(2)
    v_mfma_f32_32x32x16_bf16 v[96:111], v[68:71], v[212:215], v[96:111]
    ds_read_b64_tr_b16 v[76:77], v9 offset:40960
    ds_read_b64_tr_b16 v[78:79], v9 offset:41472
    buffer_store_dwordx4 v[32:35], v27, s[16:19], s63 offen offset:1024 sc1
    v_max3_f32 v61, v61, v88, v89
    v_max3_f32 v60, v60, v90, v91
    v_max3_f32 v61, v61, v92, v93
    v_max3_f32 v60, v60, v94, v95
    v_max_f32 v60, v60, v61
    v_mul_f32 v60, v60, v25
    v_fma_f32 v80, v80, v25, -v60
    s_setprio 0
    s_waitcnt lgkmcnt(2)
    v_mfma_f32_32x32x16_bf16 v[96:111], v[72:75], v[216:219], v[96:111]
    ds_read_b64_tr_b16 v[64:65], v6 offset:49152
    ds_read_b64_tr_b16 v[66:67], v6 offset:49664
    v_fma_f32 v81, v81, v25, -v60
    v_fma_f32 v82, v82, v25, -v60
    v_fma_f32 v83, v83, v25, -v60
    v_fma_f32 v84, v84, v25, -v60
    v_fma_f32 v85, v85, v25, -v60
    v_fma_f32 v86, v86, v25, -v60
    v_fma_f32 v87, v87, v25, -v60
    s_and_b32 s47, s4, 7
    s_lshl_b32 s47, s47, 1
    s_and_b32 s48, s5, 1
    s_add_u32 s47, s47, s48
    s_lshl_b32 s47, s47, 3
    s_add_u32 s65, s47, s3
    s_add_u32 s47, s65, 0
    s_min_u32 s47, s47, 447
    s_mul_i32 s48, s6, 448
    s_add_u32 s47, s47, s48
    s_lshl_b32 s47, s47, 10
    buffer_load_dword v15, v27, s[12:15], s47 offen
    s_waitcnt lgkmcnt(2)
    v_mfma_f32_32x32x16_bf16 v[96:111], v[76:79], v[220:223], v[96:111]
    ds_read_b64_tr_b16 v[68:69], v7 offset:49152
    ds_read_b64_tr_b16 v[70:71], v7 offset:49664
    v_fma_f32 v88, v88, v25, -v60
    v_fma_f32 v89, v89, v25, -v60
    v_fma_f32 v90, v90, v25, -v60
    v_fma_f32 v91, v91, v25, -v60
    v_fma_f32 v92, v92, v25, -v60
    v_fma_f32 v93, v93, v25, -v60
    v_fma_f32 v94, v94, v25, -v60
    s_setprio 3
    s_waitcnt lgkmcnt(2)
    v_mfma_f32_32x32x16_bf16 v[96:111], v[64:67], v[224:227], v[96:111]
    ds_read_b64_tr_b16 v[72:73], v8 offset:49152
    ds_read_b64_tr_b16 v[74:75], v8 offset:49664
    v_mfma_f32_16x16x32_bf16 v[40:43], v[36:39], v[64:67], v[40:43]
    v_fma_f32 v95, v95, v25, -v60
    v_exp_f32 v80, v80
    v_exp_f32 v81, v81
    v_exp_f32 v82, v82
    v_exp_f32 v83, v83
    v_exp_f32 v84, v84
    v_exp_f32 v85, v85
    s_add_u32 s47, s65, 128
    s_min_u32 s47, s47, 447
    s_mul_i32 s48, s6, 448
    s_add_u32 s47, s47, s48
    s_lshl_b32 s47, s47, 10
    buffer_load_dword v15, v27, s[12:15], s47 offen
    s_waitcnt lgkmcnt(2)
    v_mfma_f32_32x32x16_bf16 v[96:111], v[68:71], v[228:231], v[96:111]
    ds_read_b64_tr_b16 v[76:77], v9 offset:49152
    ds_read_b64_tr_b16 v[78:79], v9 offset:49664
    v_exp_f32 v86, v86
    v_exp_f32 v87, v87
    v_exp_f32 v88, v88
    v_exp_f32 v89, v89
    v_exp_f32 v90, v90
    v_exp_f32 v91, v91
    v_exp_f32 v92, v92
    s_setprio 2
    s_waitcnt lgkmcnt(2)
    v_mfma_f32_32x32x16_bf16 v[96:111], v[72:75], v[232:235], v[96:111]
    ds_read_b64_tr_b16 v[64:65], v6 offset:57344
    ds_read_b64_tr_b16 v[66:67], v6 offset:57856
    v_exp_f32 v93, v93
    v_exp_f32 v94, v94
    v_exp_f32 v95, v95
    v_add_f32 v60, v80, v81
    v_add_f32 v61, v82, v83
    v_add_f32 v60, v60, v84
    v_add_f32 v61, v61, v85
    s_add_u32 s47, s65, 256
    s_min_u32 s47, s47, 447
    s_mul_i32 s48, s6, 448
    s_add_u32 s47, s47, s48
    s_lshl_b32 s47, s47, 10
    buffer_load_dword v15, v27, s[12:15], s47 offen
    s_waitcnt lgkmcnt(2)
    v_mfma_f32_32x32x16_bf16 v[96:111], v[76:79], v[236:239], v[96:111]
    ds_read_b64_tr_b16 v[68:69], v7 offset:57344
    ds_read_b64_tr_b16 v[70:71], v7 offset:57856
    v_add_f32 v60, v60, v86
    v_add_f32 v61, v61, v87
    v_add_f32 v60, v60, v88
    v_add_f32 v61, v61, v89
    v_add_f32 v60, v60, v90
    v_add_f32 v61, v61, v91
    v_add_f32 v60, v60, v92
    s_setprio 1
    s_waitcnt lgkmcnt(2)
    v_mfma_f32_32x32x16_bf16 v[96:111], v[64:67], v[240:243], v[96:111]
    ds_read_b64_tr_b16 v[72:73], v8 offset:57344
    ds_read_b64_tr_b16 v[74:75], v8 offset:57856
    v_mfma_f32_16x16x32_bf16 v[40:43], v[36:39], v[64:67], v[40:43]
    v_add_f32 v61, v61, v93
    v_add_f32 v60, v60, v94
    v_add_f32 v61, v61, v95
    v_add_f32 v60, v60, v61
    v_rcp_f32 v60, v60
    s_nop 0
    v_mul_f32 v80, v80, v60
    v_mul_f32 v81, v81, v60
    s_add_u32 s47, s65, 384
    s_min_u32 s47, s47, 447
    s_mul_i32 s48, s6, 448
    s_add_u32 s47, s47, s48
    s_lshl_b32 s47, s47, 10
    buffer_load_dword v15, v27, s[12:15], s47 offen
    s_waitcnt lgkmcnt(2)
    v_mfma_f32_32x32x16_bf16 v[96:111], v[68:71], v[244:247], v[96:111]
    ds_read_b64_tr_b16 v[76:77], v9 offset:57344
    ds_read_b64_tr_b16 v[78:79], v9 offset:57856
    v_add_u32 v41, s58, v0
    ds_write_b32 v41, v40 offset:1024
    v_mul_f32 v82, v82, v60
    v_mul_f32 v83, v83, v60
    v_mul_f32 v84, v84, v60
    v_mul_f32 v85, v85, v60
    v_mul_f32 v86, v86, v60
    v_mul_f32 v87, v87, v60
    v_mul_f32 v88, v88, v60
    s_cmp_eq_u32 s3, 7
    s_cbranch_scc0 L_nca
    s_waitcnt vmcnt(13)
    v_mov_b32 v14, v14
    s_mov_b32 s57, 0
L_ncsa:
    v_cmp_ne_u32 vcc, 1, v14
    s_add_u32 s57, s57, 1
    s_cbranch_vccz L_ncsa_ok
    s_cmp_gt_u32 s57, 32768
    s_cbranch_scc1 L_ncsa_ok
    s_sleep 1
    v_and_b32 v14, 28, v1
    buffer_load_dword v14, v14, s[28:31], 0 offen sc1
    s_waitcnt vmcnt(0)
    s_branch L_ncsa
L_ncsa_ok:
L_nca:
    s_setprio 0
    s_waitcnt lgkmcnt(3)
    v_mfma_f32_32x32x16_bf16 v[96:111], v[72:75], v[248:251], v[96:111]
    s_waitcnt vmcnt(8) lgkmcnt(0)
    s_barrier
    v_xor_b32 v6, 65536, v6
    ds_read_b64_tr_b16 v[64:65], v6 offset:0
    ds_read_b64_tr_b16 v[66:67], v6 offset:512
    ds_write_b128 v26, v[52:55]
    v_xor_b32 v19, 16, v26
    ds_read_b128 v[40:43], v0 offset:1024
    v_mul_f32 v89, v89, v60
    v_mul_f32 v90, v90, v60
    v_mul_f32 v91, v91, v60
    v_mul_f32 v92, v92, v60
    v_mul_f32 v93, v93, v60
    v_mul_f32 v94, v94, v60
    v_mul_f32 v95, v95, v60
    s_lshl_b32 s48, s6, 7
    s_add_u32 s47, s65, s48
    s_lshl_b32 s47, s47, 10
    buffer_load_dword v15, v27, s[36:39], s47 offen
    buffer_load_dword v15, v27, s[92:95], 0 offen
    v_mfma_f32_32x32x16_bf16 v[96:111], v[76:79], v[252:255], v[96:111]
    v_xor_b32 v7, 65536, v7
    ds_read_b64_tr_b16 v[68:69], v7 offset:0
    ds_read_b64_tr_b16 v[70:71], v7 offset:512
    v_mov_b32 v34, 0
    v_mov_b32 v35, 0
    ds_write_b128 v19, v[56:59]
    v_cvt_pk_bf16_f32 v44, v80, v81
    v_cvt_pk_bf16_f32 v45, v82, v83
    v_cvt_pk_bf16_f32 v46, v84, v85
    v_cvt_pk_bf16_f32 v47, v86, v87
    v_cvt_pk_bf16_f32 v48, v88, v89
    v_cvt_pk_bf16_f32 v49, v90, v91
    v_cvt_pk_bf16_f32 v50, v92, v93
    v_cvt_pk_bf16_f32 v51, v94, v95
    s_setprio 3
    s_waitcnt lgkmcnt(5)
    v_mfma_f32_32x32x16_bf16 v[112:127], v[64:67], v[128:131], 0
    s_waitcnt lgkmcnt(3)
    v_add_f32 v22, v40, v41
    v_add_f32 v42, v42, v43
    v_add_f32 v22, v22, v42
    v_xor_b32 v8, 65536, v8
    ds_read_b64_tr_b16 v[72:73], v8 offset:0
    ds_read_b64_tr_b16 v[74:75], v8 offset:512
    v_mfma_f32_16x16x32_bf16 v[40:43], v[36:39], v[64:67], 0
    v_cvt_pk_bf16_f32 v32, v22, v22
    v_and_b32 v62, 0xffff0000, v32
    v_sub_f32 v62, v22, v62
    v_cvt_pk_bf16_f32 v33, v62, 0
    s_nop 1
    v_mfma_f32_32x32x16_bf16 v[96:111], v[32:35], v[28:31], v[96:111]
    s_waitcnt lgkmcnt(3)
    v_mfma_f32_32x32x16_bf16 v[112:127], v[68:71], v[132:135], v[112:127]
    v_xor_b32 v9, 65536, v9
    ds_read_b64_tr_b16 v[76:77], v9 offset:0
    ds_read_b64_tr_b16 v[78:79], v9 offset:512
    ds_write_b128 v26, v[44:47] offset:8192
    s_add_u32 s100, s98, 0
    s_and_b32 s100, s100, 3
    s_add_u32 s100, s100, s64
    s_lshl_b32 s100, s100, 14
    s_add_u32 m0, s49, 131072
    s_add_u32 s100, s100, s90
    buffer_load_dwordx4 v17, s[12:15], s100 offen lds
    s_setprio 2
    s_waitcnt lgkmcnt(3)
    v_mfma_f32_32x32x16_bf16 v[112:127], v[72:75], v[136:139], v[112:127]
    ds_read_b64_tr_b16 v[64:65], v6 offset:8192
    ds_read_b64_tr_b16 v[66:67], v6 offset:8704
    ds_write_b128 v19, v[48:51] offset:8192
    v_mul_f32 v96, v96, v23
    v_mul_f32 v97, v97, v23
    v_mul_f32 v98, v98, v23
    v_mul_f32 v99, v99, v23
    v_mul_f32 v100, v100, v23
    v_mul_f32 v101, v101, v23
    s_waitcnt lgkmcnt(4)
    v_mfma_f32_32x32x16_bf16 v[112:127], v[76:79], v[140:143], v[112:127]
    ds_read_b64_tr_b16 v[68:69], v7 offset:8192
    ds_read_b64_tr_b16 v[70:71], v7 offset:8704
    v_mul_f32 v102, v102, v23
    v_mul_f32 v103, v103, v23
    v_mul_f32 v104, v104, v23
    v_mul_f32 v105, v105, v23
    v_mul_f32 v106, v106, v23
    v_mul_f32 v107, v107, v23
    v_mul_f32 v108, v108, v23
    s_setprio 1
    s_waitcnt lgkmcnt(3)
    v_mfma_f32_32x32x16_bf16 v[112:127], v[64:67], v[144:147], v[112:127]
    ds_read_b64_tr_b16 v[72:73], v8 offset:8192
    ds_read_b64_tr_b16 v[74:75], v8 offset:8704
    v_mfma_f32_16x16x32_bf16 v[40:43], v[36:39], v[64:67], v[40:43]
    v_mul_f32 v109, v109, v23
    v_mul_f32 v110, v110, v23
    v_mul_f32 v111, v111, v23
    v_cvt_pk_bf16_f32 v96, v96, v97
    v_cvt_pk_bf16_f32 v97, v98, v99
    v_cvt_pk_bf16_f32 v98, v100, v101
    v_cvt_pk_bf16_f32 v99, v102, v103
    s_add_u32 s100, s98, 1
    s_and_b32 s100, s100, 3
    s_add_u32 s100, s100, s64
    s_lshl_b32 s100, s100, 14
    s_add_u32 m0, s49, 135168
    s_add_u32 s100, s100, s90
    buffer_load_dwordx4 v17, s[12:15], s100 offen lds
    s_waitcnt lgkmcnt(2)
    v_mfma_f32_32x32x16_bf16 v[112:127], v[68:71], v[148:151], v[112:127]
    ds_read_b64_tr_b16 v[76:77], v9 offset:8192
    ds_read_b64_tr_b16 v[78:79], v9 offset:8704
    v_cvt_pk_bf16_f32 v100, v104, v105
    v_cvt_pk_bf16_f32 v101, v106, v107
    v_cvt_pk_bf16_f32 v102, v108, v109
    v_cvt_pk_bf16_f32 v103, v110, v111
    ds_write_b128 v18, v[96:99]
    s_nop 1
    v_xor_b32 v18, 32, v18
    ds_write_b128 v18, v[100:103]
    s_waitcnt vmcnt(10) lgkmcnt(0)
    s_barrier
    s_cmp_eq_u32 s3, 7
    s_cbranch_scc0 L_nkf
    s_lshl_b32 s47, s5, 8
    s_lshl_b32 s48, s4, 2
    s_add_u32 s47, s47, s48
    s_add_u32 s47, s47, 12615680
    v_mov_b32 v13, 1
    buffer_store_dword v13, v12, s[16:19], s47 offen sc1
L_nkf:
    s_cmp_lt_u32 s3, 4
    s_cbranch_scc0 L_nkv
    s_setprio 3
    v_bfe_u32 v20, v1, 2, 2
    v_lshrrev_b32 v21, 5, v1
    v_lshl_add_u32 v20, v21, 3, v20
    v_lshlrev_b32 v20, 6, v20
    v_bfe_u32 v21, v1, 1, 1
    v_lshl_add_u32 v20, v21, 3, v20
    v_bfe_u32 v21, v1, 3, 1
    v_and_b32 v19, 1, v1
    v_or_b32 v60, s99, v19
    v_xor_b32 v60, v60, v21
    v_lshl_add_u32 v60, v60, 4, v20
    s_lshr_b32 s47, s3, 1
    s_lshl_b32 s47, s47, 13
    s_add_u32 s47, s47, 32768
    v_add_u32 v60, s47, v60
    v_xor_b32 v61, 32, v60
    v_bfe_u32 v62, v1, 4, 1
    v_lshl_add_u32 v62, v19, 1, v62
    v_xor_b32 v62, v62, v21
    v_lshl_add_u32 v62, v62, 4, v20
    s_lshl_b32 s47, s3, 13
    v_add_u32 v62, s47, v62
    v_xor_b32 v63, 32, v62
    v_and_b32 v20, 16, v1
    v_cmp_eq_u32 vcc, 0, v20
    v_mov_b32 v21, s50
    ds_read_b64_tr_b16 v[44:45], v60 offset:0
    ds_read_b64_tr_b16 v[48:49], v62 offset:0
    ds_read_b64_tr_b16 v[46:47], v61 offset:256
    ds_read_b64_tr_b16 v[50:51], v63 offset:256
    ds_read_b64_tr_b16 v[52:53], v60 offset:1024
    ds_read_b64_tr_b16 v[56:57], v62 offset:1024
    ds_read_b64_tr_b16 v[54:55], v61 offset:1280
    ds_read_b64_tr_b16 v[58:59], v63 offset:1280
    ds_read_b64_tr_b16 v[96:97], v60 offset:2048
    ds_read_b64_tr_b16 v[100:101], v62 offset:2048
    ds_read_b64_tr_b16 v[98:99], v61 offset:2304
    ds_read_b64_tr_b16 v[102:103], v63 offset:2304
    s_waitcnt lgkmcnt(11)
    v_cndmask_b32 v44, v21, v44, vcc
    v_cndmask_b32 v45, v21, v45, vcc
    s_waitcnt lgkmcnt(9)
    v_cndmask_b32 v46, v21, v46, vcc
    v_cndmask_b32 v47, v21, v47, vcc
    ds_read_b64_tr_b16 v[104:105], v60 offset:3072
    ds_read_b64_tr_b16 v[108:109], v62 offset:3072
    ds_read_b64_tr_b16 v[106:107], v61 offset:3328
    ds_read_b64_tr_b16 v[110:111], v63 offset:3328
    s_waitcnt lgkmcnt(12)
    v_mfma_f32_32x32x16_bf16 v[80:95], v[48:51], v[44:47], 0
    s_waitcnt lgkmcnt(11)
    v_cndmask_b32 v52, v21, v52, vcc
    v_cndmask_b32 v53, v21, v53, vcc
    s_waitcnt lgkmcnt(9)
    v_cndmask_b32 v54, v21, v54, vcc
    v_cndmask_b32 v55, v21, v55, vcc
    ds_read_b64_tr_b16 v[44:45], v60 offset:4096
    ds_read_b64_tr_b16 v[48:49], v62 offset:4096
    ds_read_b64_tr_b16 v[46:47], v61 offset:4352
    ds_read_b64_tr_b16 v[50:51], v63 offset:4352
    s_waitcnt lgkmcnt(12)
    v_mfma_f32_32x32x16_bf16 v[80:95], v[56:59], v[52:55], v[80:95]
    s_waitcnt lgkmcnt(11)
    v_cndmask_b32 v96, v21, v96, vcc
    v_cndmask_b32 v97, v21, v97, vcc
    s_waitcnt lgkmcnt(9)
    v_cndmask_b32 v98, v21, v98, vcc
    v_cndmask_b32 v99, v21, v99, vcc
    ds_read_b64_tr_b16 v[52:53], v60 offset:5120
    ds_read_b64_tr_b16 v[56:57], v62 offset:5120
    ds_read_b64_tr_b16 v[54:55], v61 offset:5376
    ds_read_b64_tr_b16 v[58:59], v63 offset:5376
    s_waitcnt lgkmcnt(12)
    v_mfma_f32_32x32x16_bf16 v[80:95], v[100:103], v[96:99], v[80:95]
    s_waitcnt lgkmcnt(11)
    v_cndmask_b32 v104, v21, v104, vcc
    v_cndmask_b32 v105, v21, v105, vcc
    s_waitcnt lgkmcnt(9)
    v_cndmask_b32 v106, v21, v106, vcc
    v_cndmask_b32 v107, v21, v107, vcc
    ds_read_b64_tr_b16 v[96:97], v60 offset:6144
    ds_read_b64_tr_b16 v[100:101], v62 offset:6144
    ds_read_b64_tr_b16 v[98:99], v61 offset:6400
    ds_read_b64_tr_b16 v[102:103], v63 offset:6400
    s_waitcnt lgkmcnt(12)
    v_mfma_f32_32x32x16_bf16 v[80:95], v[108:111], v[104:107], v[80:95]
    s_waitcnt lgkmcnt(11)
    v_cndmask_b32 v44, v21, v44, vcc
    v_cndmask_b32 v45, v21, v45, vcc
    s_waitcnt lgkmcnt(9)
    v_cndmask_b32 v46, v21, v46, vcc
    v_cndmask_b32 v47, v21, v47, vcc
    ds_read_b64_tr_b16 v[104:105], v60 offset:7168
    ds_read_b64_tr_b16 v[108:109], v62 offset:7168
    ds_read_b64_tr_b16 v[106:107], v61 offset:7424
    ds_read_b64_tr_b16 v[110:111], v63 offset:7424
    s_waitcnt lgkmcnt(12)
    v_mfma_f32_32x32x16_bf16 v[80:95], v[48:51], v[44:47], v[80:95]
    s_waitcnt lgkmcnt(11)
    v_cndmask_b32 v52, v21, v52, vcc
    v_cndmask_b32 v53, v21, v53, vcc
    s_waitcnt lgkmcnt(9)
    v_cndmask_b32 v54, v21, v54, vcc
    v_cndmask_b32 v55, v21, v55, vcc
    s_waitcnt lgkmcnt(8)
    s_nop 0
    v_mfma_f32_32x32x16_bf16 v[80:95], v[56:59], v[52:55], v[80:95]
    s_waitcnt lgkmcnt(7)
    v_cndmask_b32 v96, v21, v96, vcc
    v_cndmask_b32 v97, v21, v97, vcc
    s_waitcnt lgkmcnt(5)
    v_cndmask_b32 v98, v21, v98, vcc
    v_cndmask_b32 v99, v21, v99, vcc
    s_waitcnt lgkmcnt(4)
    s_nop 0
    v_mfma_f32_32x32x16_bf16 v[80:95], v[100:103], v[96:99], v[80:95]
    s_waitcnt lgkmcnt(3)
    v_cndmask_b32 v104, v21, v104, vcc
    v_cndmask_b32 v105, v21, v105, vcc
    s_waitcnt lgkmcnt(1)
    v_cndmask_b32 v106, v21, v106, vcc
    v_cndmask_b32 v107, v21, v107, vcc
    s_waitcnt lgkmcnt(0)
    s_nop 0
    v_mfma_f32_32x32x16_bf16 v[80:95], v[108:111], v[104:107], v[80:95]
    v_lshrrev_b32 v20, 5, v1
    v_and_b32 v62, 15, v1
    v_lshlrev_b32 v60, 4, v62
    v_lshl_add_u32 v60, v20, 8, v60
    v_add_u32 v61, 512, v60
    v_lshlrev_b32 v20, 4, v20
    v_add_u32 v20, 1024, v20
    v_lshl_add_u32 v20, v62, 26, v20
    v_add_u32 v21, 32, v20
    v_cndmask_b32 v60, v20, v60, vcc
    v_cndmask_b32 v61, v21, v61, vcc
    s_nop 0
    v_cvt_pk_bf16_f32 v44, v80, v81
    v_cvt_pk_bf16_f32 v45, v82, v83
    v_cvt_pk_bf16_f32 v46, v84, v85
    v_cvt_pk_bf16_f32 v47, v86, v87
    v_cvt_pk_bf16_f32 v48, v88, v89
    v_cvt_pk_bf16_f32 v49, v90, v91
    v_cvt_pk_bf16_f32 v50, v92, v93
    v_cvt_pk_bf16_f32 v51, v94, v95
    buffer_store_dwordx4 v[44:47], v60, s[16:19], s62 offen sc1
    buffer_store_dwordx4 v[48:51], v61, s[16:19], s62 offen sc1
L_nkv:
    s_setprio 0
    v_mfma_f32_32x32x16_bf16 v[112:127], v[72:75], v[152:155], v[112:127]
    ds_read_b64_tr_b16 v[64:65], v6 offset:16384
    ds_read_b64_tr_b16 v[66:67], v6 offset:16896
    v_mfma_f32_32x32x16_bf16 v[112:127], v[76:79], v[156:159], v[112:127]
    ds_read_b64_tr_b16 v[68:69], v7 offset:16384
    ds_read_b64_tr_b16 v[70:71], v7 offset:16896
    v_mov_b32 v32, -1
    v_mov_b32 v33, -1
    v_mov_b32 v34, -1
    v_mov_b32 v35, -1
    s_setprio 3
    s_waitcnt lgkmcnt(2)
    v_mfma_f32_32x32x16_bf16 v[112:127], v[64:67], v[160:163], v[112:127]
    ds_read_b64_tr_b16 v[72:73], v8 offset:16384
    ds_read_b64_tr_b16 v[74:75], v8 offset:16896
    v_mfma_f32_16x16x32_bf16 v[40:43], v[36:39], v[64:67], v[40:43]
    s_xor_b32 s47, s2, 1
    s_mul_i32 s47, s47, 24576
    s_lshl_b32 s48, s3, 10
    s_add_u32 s47, s47, s48
    s_add_u32 s47, s47, 16777216
    buffer_store_dwordx4 v[32:35], v27, s[16:19], s47 offen sc1
    s_waitcnt lgkmcnt(2)
    v_mfma_f32_32x32x16_bf16 v[112:127], v[68:71], v[164:167], v[112:127]
    ds_read_b64_tr_b16 v[76:77], v9 offset:16384
    ds_read_b64_tr_b16 v[78:79], v9 offset:16896
    s_setprio 2
    s_waitcnt lgkmcnt(2)
    v_mfma_f32_32x32x16_bf16 v[112:127], v[72:75], v[168:171], v[112:127]
    ds_read_b64_tr_b16 v[64:65], v6 offset:24576
    ds_read_b64_tr_b16 v[66:67], v6 offset:25088
    s_add_u32 s100, s98, 2
    s_and_b32 s100, s100, 3
    s_add_u32 s100, s100, s64
    s_lshl_b32 s100, s100, 14
    s_add_u32 m0, s49, 49152
    s_add_u32 s100, s100, s90
    buffer_load_dwordx4 v17, s[12:15], s100 offen lds
    s_waitcnt lgkmcnt(2)
    v_mfma_f32_32x32x16_bf16 v[112:127], v[76:79], v[172:175], v[112:127]
    ds_read_b64_tr_b16 v[68:69], v7 offset:24576
    ds_read_b64_tr_b16 v[70:71], v7 offset:25088
    s_setprio 1
    s_waitcnt lgkmcnt(2)
    v_mfma_f32_32x32x16_bf16 v[112:127], v[64:67], v[176:179], v[112:127]
    ds_read_b64_tr_b16 v[72:73], v8 offset:24576
    ds_read_b64_tr_b16 v[74:75], v8 offset:25088
    v_mfma_f32_16x16x32_bf16 v[40:43], v[36:39], v[64:67], v[40:43]
    s_xor_b32 s47, s2, 2
    s_mul_i32 s47, s47, 24576
    s_lshl_b32 s48, s3, 10
    s_add_u32 s47, s47, s48
    s_add_u32 s47, s47, 16785408
    buffer_store_dwordx4 v[32:35], v27, s[16:19], s47 offen sc1
    s_mul_i32 s65, s5, 73728
    s_lshr_b32 s47, s3, 1
    s_mul_i32 s47, s47, 1152
    s_add_u32 s65, s65, s47
    s_add_u32 s65, s65, 10485760
    v_and_b32 v21, 15, v1
    v_mul_u32_u24 v21, 4608, v21
    v_and_b32 v20, 16, v1
    v_add_u32 v21, v21, v20
    s_lshl_b32 s47, s99, 4
    v_add_u32 v21, s47, v21
    v_lshrrev_b32 v20, 5, v1
    v_mul_u32_u24 v20, 36352, v20
    v_add_u32 v20, v20, v27
    s_lshl_b32 s47, s99, 8
    v_add_u32 v20, s47, v20
    s_waitcnt lgkmcnt(2)
    v_mfma_f32_32x32x16_bf16 v[112:127], v[68:71], v[180:183], v[112:127]
    ds_read_b64_tr_b16 v[76:77], v9 offset:24576
    ds_read_b64_tr_b16 v[78:79], v9 offset:25088
    s_setprio 0
    s_waitcnt lgkmcnt(2)
    v_mfma_f32_32x32x16_bf16 v[112:127], v[72:75], v[184:187], v[112:127]
    ds_read_b64_tr_b16 v[64:65], v6 offset:32768
    ds_read_b64_tr_b16 v[66:67], v6 offset:33280
    s_add_u32 s100, s98, 3
    s_and_b32 s100, s100, 3
    s_add_u32 s100, s100, s64
    s_lshl_b32 s100, s100, 14
    s_add_u32 m0, s49, 53248
    s_add_u32 s100, s100, s90
    buffer_load_dwordx4 v17, s[12:15], s100 offen lds
    s_waitcnt lgkmcnt(2)
    v_mfma_f32_32x32x16_bf16 v[112:127], v[76:79], v[188:191], v[112:127]
    ds_read_b64_tr_b16 v[68:69], v7 offset:32768
    ds_read_b64_tr_b16 v[70:71], v7 offset:33280
    s_setprio 3
    s_waitcnt lgkmcnt(2)
    v_mfma_f32_32x32x16_bf16 v[112:127], v[64:67], v[192:195], v[112:127]
    ds_read_b64_tr_b16 v[72:73], v8 offset:32768
    ds_read_b64_tr_b16 v[74:75], v8 offset:33280
    v_mfma_f32_16x16x32_bf16 v[40:43], v[36:39], v[64:67], v[40:43]
    s_waitcnt vmcnt(12)
    v_mov_b32 v13, 1
    buffer_store_dword v13, v12, s[16:19], s51 offen sc1
    ds_read_b64_tr_b16 v[52:53], v10 offset:512
    ds_read_b64_tr_b16 v[54:55], v10 offset:768
    s_waitcnt lgkmcnt(4)
    v_mfma_f32_32x32x16_bf16 v[112:127], v[68:71], v[196:199], v[112:127]
    ds_read_b64_tr_b16 v[76:77], v9 offset:32768
    ds_read_b64_tr_b16 v[78:79], v9 offset:33280
    s_xor_b32 s47, s2, 3
    s_mul_i32 s47, s47, 24576
    s_lshl_b32 s48, s3, 10
    s_add_u32 s47, s47, s48
    s_add_u32 s47, s47, 16793600
    buffer_store_dwordx4 v[32:35], v27, s[16:19], s47 offen sc1
    s_setprio 2
    s_waitcnt lgkmcnt(4)
    v_mfma_f32_32x32x16_bf16 v[112:127], v[72:75], v[200:203], v[112:127]
    ds_read_b64_tr_b16 v[64:65], v6 offset:40960
    ds_read_b64_tr_b16 v[66:67], v6 offset:41472
    s_waitcnt lgkmcnt(5)
    v_xor_b32 v52, v11, v52
    v_xor_b32 v53, v11, v53
    s_waitcnt lgkmcnt(4)
    v_xor_b32 v54, v11, v54
    v_xor_b32 v55, v11, v55
    s_waitcnt lgkmcnt(2)
    v_mfma_f32_32x32x16_bf16 v[112:127], v[76:79], v[204:207], v[112:127]
    ds_read_b64_tr_b16 v[68:69], v7 offset:40960
    ds_read_b64_tr_b16 v[70:71], v7 offset:41472
    v_mov_b32 v34, 0
    v_mov_b32 v35, 0
    s_setprio 1
    s_waitcnt lgkmcnt(2)
    v_mfma_f32_32x32x16_bf16 v[112:127], v[64:67], v[208:211], v[112:127]
    ds_read_b64_tr_b16 v[72:73], v8 offset:40960
    ds_read_b64_tr_b16 v[74:75], v8 offset:41472
    v_mfma_f32_16x16x32_bf16 v[40:43], v[36:39], v[64:67], v[40:43]
    s_waitcnt lgkmcnt(2)
    v_mfma_f32_32x32x16_bf16 v[112:127], v[68:71], v[212:215], v[112:127]
    ds_read_b64_tr_b16 v[76:77], v9 offset:40960
    ds_read_b64_tr_b16 v[78:79], v9 offset:41472
    s_cmp_eq_u32 s3, 7
    s_cbranch_scc0 L_nkr
    s_lshl_b32 s56, s5, 8
    s_add_u32 s56, s56, 12615680
    s_buffer_load_dwordx16 s[20:35], s[16:19], s56 glc
L_nkr:
    s_cmp_eq_u32 s3, 7
    s_cbranch_scc0 L_nkp
    s_lshl_b32 s56, s5, 8
    s_add_u32 s56, s56, 12615680
    s_mov_b32 s57, 0
    s_branch L_spkv1
L_spkv:
    s_buffer_load_dwordx16 s[20:35], s[16:19], s56 glc
L_spkv1:
    s_add_u32 s57, s57, 1
    s_waitcnt lgkmcnt(0)
    s_and_b64 s[20:21], s[20:21], s[22:23]
    s_and_b64 s[20:21], s[20:21], s[24:25]
    s_and_b64 s[20:21], s[20:21], s[26:27]
    s_and_b64 s[20:21], s[20:21], s[28:29]
    s_and_b64 s[20:21], s[20:21], s[30:31]
    s_and_b64 s[20:21], s[20:21], s[32:33]
    s_and_b64 s[20:21], s[20:21], s[34:35]
    s_and_b32 s20, s20, s21
    s_cbranch_scc1 L_nkp
    s_cmp_gt_u32 s57, 32768
    s_cbranch_scc1 L_nkp
    s_sleep 1
    s_branch L_spkv
L_nkp:
    s_setprio 0
    s_waitcnt lgkmcnt(2)
    v_mfma_f32_32x32x16_bf16 v[112:127], v[72:75], v[216:219], v[112:127]
    s_barrier
    ds_read_b64_tr_b16 v[64:65], v6 offset:49152
    ds_read_b64_tr_b16 v[66:67], v6 offset:49664
    s_add_u32 s100, s98, 4
    s_and_b32 s100, s100, 3
    s_add_u32 s100, s100, s64
    s_add_u32 s100, s100, 4
    s_lshl_b32 s100, s100, 14
    s_add_u32 m0, s49, 0
    s_add_u32 s100, s100, s90
    buffer_load_dwordx4 v17, s[12:15], s100 offen lds
    s_waitcnt lgkmcnt(2)
    v_mfma_f32_32x32x16_bf16 v[112:127], v[76:79], v[220:223], v[112:127]
    ds_read_b64_tr_b16 v[68:69], v7 offset:49152
    ds_read_b64_tr_b16 v[70:71], v7 offset:49664
    s_add_u32 s100, s98, 5
    s_and_b32 s100, s100, 3
    s_add_u32 s100, s100, s64
    s_add_u32 s100, s100, 4
    s_lshl_b32 s100, s100, 14
    s_add_u32 m0, s49, 4096
    s_add_u32 s100, s100, s90
    buffer_load_dwordx4 v17, s[12:15], s100 offen lds
    s_setprio 3
    s_waitcnt lgkmcnt(2)
    v_mfma_f32_32x32x16_bf16 v[112:127], v[64:67], v[224:227], v[112:127]
    ds_read_b64_tr_b16 v[72:73], v8 offset:49152
    ds_read_b64_tr_b16 v[74:75], v8 offset:49664
    v_mfma_f32_16x16x32_bf16 v[40:43], v[36:39], v[64:67], v[40:43]
    s_add_u32 s100, s98, 6
    s_and_b32 s100, s100, 3
    s_add_u32 s100, s100, s64
    s_add_u32 s100, s100, 4
    s_lshl_b32 s100, s100, 14
    s_add_u32 m0, s49, 16384
    s_add_u32 s100, s100, s90
    buffer_load_dwordx4 v17, s[12:15], s100 offen lds
    s_waitcnt lgkmcnt(2)
    v_mfma_f32_32x32x16_bf16 v[112:127], v[68:71], v[228:231], v[112:127]
    ds_read_b64_tr_b16 v[76:77], v9 offset:49152
    ds_read_b64_tr_b16 v[78:79], v9 offset:49664
    s_add_u32 s100, s98, 7
    s_and_b32 s100, s100, 3
    s_add_u32 s100, s100, s64
    s_add_u32 s100, s100, 4
    s_lshl_b32 s100, s100, 14
    s_add_u32 m0, s49, 20480
    s_add_u32 s100, s100, s90
    buffer_load_dwordx4 v17, s[12:15], s100 offen lds
    s_setprio 2
    s_waitcnt lgkmcnt(2)
    v_mfma_f32_32x32x16_bf16 v[112:127], v[72:75], v[232:235], v[112:127]
    ds_read_b64_tr_b16 v[64:65], v6 offset:57344
    ds_read_b64_tr_b16 v[66:67], v6 offset:57856
    s_add_u32 s100, s98, 8
    s_and_b32 s100, s100, 3
    s_add_u32 s100, s100, s64
    s_add_u32 s100, s100, 8
    s_lshl_b32 s100, s100, 14
    s_add_u32 m0, s49, 32768
    s_add_u32 s100, s100, s90
    buffer_load_dwordx4 v17, s[12:15], s100 offen lds
    s_waitcnt lgkmcnt(2)
    v_mfma_f32_32x32x16_bf16 v[112:127], v[76:79], v[236:239], v[112:127]
    ds_read_b64_tr_b16 v[68:69], v7 offset:57344
    ds_read_b64_tr_b16 v[70:71], v7 offset:57856
    s_add_u32 s100, s98, 9
    s_and_b32 s100, s100, 3
    s_add_u32 s100, s100, s64
    s_add_u32 s100, s100, 8
    s_lshl_b32 s100, s100, 14
    s_add_u32 m0, s49, 36864
    s_add_u32 s100, s100, s90
    buffer_load_dwordx4 v17, s[12:15], s100 offen lds
    s_setprio 1
    s_waitcnt lgkmcnt(2)
    v_mfma_f32_32x32x16_bf16 v[112:127], v[64:67], v[240:243], v[112:127]
    ds_read_b64_tr_b16 v[72:73], v8 offset:57344
    ds_read_b64_tr_b16 v[74:75], v8 offset:57856
    v_mfma_f32_16x16x32_bf16 v[40:43], v[36:39], v[64:67], v[40:43]
    s_waitcnt lgkmcnt(2)
    v_mfma_f32_32x32x16_bf16 v[112:127], v[68:71], v[244:247], v[112:127]
    ds_read_b64_tr_b16 v[76:77], v9 offset:57344
    ds_read_b64_tr_b16 v[78:79], v9 offset:57856
    s_nop 3
    v_add_u32 v41, s58, v0
    ds_write_b32 v41, v40 offset:2048
    s_setprio 0
    s_waitcnt lgkmcnt(3)
    v_mfma_f32_32x32x16_bf16 v[112:127], v[72:75], v[248:251], v[112:127]
    s_waitcnt lgkmcnt(0)
    s_barrier
    ds_read_b128 v[56:59], v0 offset:2048
    buffer_load_dwordx4 v[208:211], v21, s[16:19], s65 offen offset:1024 sc1
    v_mfma_f32_32x32x16_bf16 v[112:127], v[76:79], v[252:255], v[112:127]
    s_buffer_load_dwordx4 s[28:31], s[16:19], s44 offset:0 glc
    s_add_u32 s101, s4, 0
    s_and_b32 s101, s101, 7
    s_mul_i32 s101, s101, 4608
    s_add_u32 s101, s101, s65
    buffer_load_dwordx4 v[128:131], v20, s[16:19], s101 offen sc1
    s_setprio 0
    s_waitcnt lgkmcnt(0)
    v_add_f32 v22, v56, v57
    v_add_f32 v58, v58, v59
    v_add_f32 v22, v22, v58
    v_cvt_pk_bf16_f32 v32, v22, v22
    v_and_b32 v62, 0xffff0000, v32
    v_sub_f32 v62, v22, v62
    v_cvt_pk_bf16_f32 v33, v62, 0
    s_nop 1
    v_mfma_f32_32x32x16_bf16 v[112:127], v[32:35], v[28:31], v[112:127]
    s_add_u32 s101, s4, 1
    s_and_b32 s101, s101, 7
    s_mul_i32 s101, s101, 4608
    s_add_u32 s101, s101, s65
    buffer_load_dwordx4 v[136:139], v20, s[16:19], s101 offen sc1
    s_add_u32 s101, s4, 2
    s_and_b32 s101, s101, 7
    s_mul_i32 s101, s101, 4608
    s_add_u32 s101, s101, s65
    buffer_load_dwordx4 v[144:147], v20, s[16:19], s101 offen sc1
    s_nop 1
    v_cvt_pk_bf16_f32 v44, v112, v113
    v_cvt_pk_bf16_f32 v45, v114, v115
    v_cvt_pk_bf16_f32 v46, v116, v117
    v_cvt_pk_bf16_f32 v47, v118, v119
    v_cvt_pk_bf16_f32 v48, v120, v121
    v_cvt_pk_bf16_f32 v49, v122, v123
    v_cvt_pk_bf16_f32 v50, v124, v125
    v_cvt_pk_bf16_f32 v51, v126, v127
    v_mfma_f32_32x32x16_bf16 v[96:111], v[2:5], v[44:47], 0
    s_nop 0
    v_mfma_f32_32x32x16_bf16 v[112:127], v[52:55], v[48:51], 0
    s_add_u32 s101, s4, 3
    s_and_b32 s101, s101, 7
    s_mul_i32 s101, s101, 4608
    s_add_u32 s101, s101, s65
    buffer_load_dwordx4 v[152:155], v20, s[16:19], s101 offen sc1
    s_nop 4
    v_max3_f32 v60, v96, v97, v98
    v_max3_f32 v61, v99, v100, v101
    v_max3_f32 v60, v60, v102, v103
    v_max3_f32 v61, v61, v104, v105
    v_max3_f32 v60, v60, v106, v107
    v_max3_f32 v61, v61, v108, v109
    s_add_u32 s101, s4, 4
    s_and_b32 s101, s101, 7
    s_mul_i32 s101, s101, 4608
    s_add_u32 s101, s101, s65
    buffer_load_dwordx4 v[160:163], v20, s[16:19], s101 offen sc1
    v_max3_f32 v60, v60, v110, v111
    v_max_f32 v60, v60, v61
    v_mul_f32 v60, v60, v25
    v_pk_fma_f32 v[96:97], v[96:97], v[24:25], v[60:61] op_sel:[0,1,0] op_sel_hi:[1,1,0] neg_lo:[0,0,1] neg_hi:[0,0,1]
    v_pk_fma_f32 v[98:99], v[98:99], v[24:25], v[60:61] op_sel:[0,1,0] op_sel_hi:[1,1,0] neg_lo:[0,0,1] neg_hi:[0,0,1]
    v_pk_fma_f32 v[100:101], v[100:101], v[24:25], v[60:61] op_sel:[0,1,0] op_sel_hi:[1,1,0] neg_lo:[0,0,1] neg_hi:[0,0,1]
    s_add_u32 s101, s4, 5
    s_and_b32 s101, s101, 7
    s_mul_i32 s101, s101, 4608
    s_add_u32 s101, s101, s65
    buffer_load_dwordx4 v[168:171], v20, s[16:19], s101 offen sc1
    v_pk_fma_f32 v[102:103], v[102:103], v[24:25], v[60:61] op_sel:[0,1,0] op_sel_hi:[1,1,0] neg_lo:[0,0,1] neg_hi:[0,0,1]
    v_pk_fma_f32 v[104:105], v[104:105], v[24:25], v[60:61] op_sel:[0,1,0] op_sel_hi:[1,1,0] neg_lo:[0,0,1] neg_hi:[0,0,1]
    v_pk_fma_f32 v[106:107], v[106:107], v[24:25], v[60:61] op_sel:[0,1,0] op_sel_hi:[1,1,0] neg_lo:[0,0,1] neg_hi:[0,0,1]
    v_pk_fma_f32 v[108:109], v[108:109], v[24:25], v[60:61] op_sel:[0,1,0] op_sel_hi:[1,1,0] neg_lo:[0,0,1] neg_hi:[0,0,1]
    v_pk_fma_f32 v[110:111], v[110:111], v[24:25], v[60:61] op_sel:[0,1,0] op_sel_hi:[1,1,0] neg_lo:[0,0,1] neg_hi:[0,0,1]
    v_exp_f32 v96, v96
    s_add_u32 s101, s4, 6
    s_and_b32 s101, s101, 7
    s_mul_i32 s101, s101, 4608
    s_add_u32 s101, s101, s65
    buffer_load_dwordx4 v[176:179], v20, s[16:19], s101 offen sc1
    v_exp_f32 v97, v97
    v_exp_f32 v98, v98
    v_exp_f32 v99, v99
    v_exp_f32 v100, v100
    v_exp_f32 v101, v101
    v_exp_f32 v102, v102
    s_add_u32 s101, s4, 7
    s_and_b32 s101, s101, 7
    s_mul_i32 s101, s101, 4608
    s_add_u32 s101, s101, s65
    buffer_load_dwordx4 v[184:187], v20, s[16:19], s101 offen sc1
    v_exp_f32 v103, v103
    v_exp_f32 v104, v104
    v_exp_f32 v105, v105
    v_exp_f32 v106, v106
    v_exp_f32 v107, v107
    v_exp_f32 v108, v108
    s_add_u32 s100, s98, 10
    s_and_b32 s100, s100, 3
    s_add_u32 s100, s100, s64
    s_add_u32 s100, s100, 8
    s_lshl_b32 s100, s100, 14
    s_add_u32 m0, s49, 65536
    s_add_u32 s100, s100, s90
    buffer_load_dwordx4 v17, s[12:15], s100 offen lds
    v_exp_f32 v109, v109
    v_exp_f32 v110, v110
    v_exp_f32 v111, v111
    v_pk_add_f32 v[60:61], v[96:97], v[98:99]
    v_pk_add_f32 v[62:63], v[100:101], v[102:103]
    v_pk_add_f32 v[60:61], v[60:61], v[104:105]
    v_pk_add_f32 v[62:63], v[62:63], v[106:107]
    v_pk_add_f32 v[60:61], v[60:61], v[108:109]
    v_pk_add_f32 v[62:63], v[62:63], v[110:111]
    v_pk_add_f32 v[60:61], v[60:61], v[62:63]
    v_add_f32 v60, v60, v61
    v_rcp_f32 v60, v60
    s_nop 0
    v_pk_mul_f32 v[96:97], v[96:97], v[60:61] op_sel_hi:[1,0]
    v_pk_mul_f32 v[98:99], v[98:99], v[60:61] op_sel_hi:[1,0]
    s_add_u32 s100, s98, 11
    s_and_b32 s100, s100, 3
    s_add_u32 s100, s100, s64
    s_add_u32 s100, s100, 8
    s_lshl_b32 s100, s100, 14
    s_add_u32 m0, s49, 69632
    s_add_u32 s100, s100, s90
    buffer_load_dwordx4 v17, s[12:15], s100 offen lds
    v_pk_mul_f32 v[100:101], v[100:101], v[60:61] op_sel_hi:[1,0]
    v_pk_mul_f32 v[102:103], v[102:103], v[60:61] op_sel_hi:[1,0]
    v_pk_mul_f32 v[104:105], v[104:105], v[60:61] op_sel_hi:[1,0]
    v_pk_mul_f32 v[106:107], v[106:107], v[60:61] op_sel_hi:[1,0]
    v_pk_mul_f32 v[108:109], v[108:109], v[60:61] op_sel_hi:[1,0]
    v_pk_mul_f32 v[110:111], v[110:111], v[60:61] op_sel_hi:[1,0]
    v_cvt_pk_bf16_f32 v64, v96, v97
    v_cvt_pk_bf16_f32 v65, v98, v99
    v_cvt_pk_bf16_f32 v66, v100, v101
    v_cvt_pk_bf16_f32 v67, v102, v103
    v_cvt_pk_bf16_f32 v68, v104, v105
    v_cvt_pk_bf16_f32 v69, v106, v107
    v_cvt_pk_bf16_f32 v70, v108, v109
    v_cvt_pk_bf16_f32 v71, v110, v111
    s_mov_b32 s57, 0
L_sp_1:
    s_waitcnt lgkmcnt(0)
    s_min_u32 s28, s28, s29
    s_min_u32 s30, s30, s31
    s_min_u32 s28, s28, s30
    s_cmp_ge_u32 s28, 1
    s_cbranch_scc1 L_sp_1_ok
    s_add_u32 s57, s57, 1
    s_cmp_gt_u32 s57, 32768
    s_cbranch_scc1 L_sp_1_ok
    s_sleep 1
    s_buffer_load_dwordx4 s[28:31], s[16:19], s44 offset:0 glc
    s_branch L_sp_1
L_sp_1_ok:
    s_buffer_load_dwordx4 s[28:31], s[16:19], s44 offset:1024 glc
    s_waitcnt vmcnt(10)
    v_max3_u32 v48, v208, v209, v210
    s_waitcnt vmcnt(9)
    v_max3_u32 v48, v48, v211, v128
    v_max3_u32 v48, v48, v129, v130
    s_waitcnt vmcnt(8)
    v_max3_u32 v48, v48, v131, v136
    v_max3_u32 v48, v48, v137, v138
    s_waitcnt vmcnt(7)
    v_max3_u32 v48, v48, v139, v144
    v_max3_u32 v48, v48, v145, v146
    s_waitcnt vmcnt(6)
    v_max3_u32 v48, v48, v147, v152
    v_max3_u32 v48, v48, v153, v154
    s_waitcnt vmcnt(5)
    v_max3_u32 v48, v48, v155, v160
    v_max3_u32 v48, v48, v161, v162
    s_waitcnt vmcnt(4)
    v_max3_u32 v48, v48, v163, v168
    v_max3_u32 v48, v48, v169, v170
    s_waitcnt vmcnt(3)
    v_max3_u32 v48, v48, v171, v176
    v_max3_u32 v48, v48, v177, v178
    s_waitcnt vmcnt(2)
    v_max3_u32 v48, v48, v179, v184
    v_max3_u32 v48, v48, v185, v186
    v_max_u32 v48, v48, v187
    v_cmp_eq_u32 vcc, -1, v48
    s_nop 0
    s_cbranch_vccnz L_v_2_slow
L_v_2_back:
    s_mul_i32 s100, s64, 6
    s_sub_u32 s100, 12, s100
    s_lshl_b32 s100, s100, 14
    s_add_u32 m0, s49, 81920
    s_add_u32 s100, s100, s90
    buffer_load_dwordx4 v17, s[12:15], s100 offen lds
    v_lshrrev_b32 v45, 5, v1
    v_bfe_u32 v46, v1, 4, 1
    v_lshlrev_b32 v46, 9, v46
    v_lshl_add_u32 v46, v45, 3, v46
    s_lshl_b32 s47, s3, 10
    s_add_u32 s47, s47, 147456
    v_add_u32 v46, s47, v46
    v_and_b32 v47, 15, v1
    v_lshl_add_u32 v47, v47, 4, v46
    v_cmp_gt_u32 vcc, 32, v1
    s_mov_b32 s47, 0x3f80
    s_mov_b32 s48, 0x3f800000
    v_cndmask_b32 v208, v210, v208, vcc
    v_cndmask_b32 v209, v211, v209, vcc
    v_lshlrev_b32 v216, 16, v208
    v_and_b32 v217, 0xffff0000, v208
    v_lshlrev_b32 v218, 16, v209
    v_and_b32 v219, 0xffff0000, v209
    v_add_f32_dpp v216, v216, v216 row_ror:8 row_mask:0xf bank_mask:0xf
    v_add_f32_dpp v217, v217, v217 row_ror:8 row_mask:0xf bank_mask:0xf
    v_add_f32_dpp v218, v218, v218 row_ror:8 row_mask:0xf bank_mask:0xf
    v_add_f32_dpp v219, v219, v219 row_ror:8 row_mask:0xf bank_mask:0xf
    v_add_f32_dpp v216, v216, v216 row_ror:4 row_mask:0xf bank_mask:0xf
    v_add_f32_dpp v217, v217, v217 row_ror:4 row_mask:0xf bank_mask:0xf
    v_add_f32_dpp v218, v218, v218 row_ror:4 row_mask:0xf bank_mask:0xf
    v_add_f32_dpp v219, v219, v219 row_ror:4 row_mask:0xf bank_mask:0xf
    v_add_f32_dpp v216, v216, v216 row_ror:2 row_mask:0xf bank_mask:0xf
    v_add_f32_dpp v217, v217, v217 row_ror:2 row_mask:0xf bank_mask:0xf
    v_add_f32_dpp v218, v218, v218 row_ror:2 row_mask:0xf bank_mask:0xf
    v_add_f32_dpp v219, v219, v219 row_ror:2 row_mask:0xf bank_mask:0xf
    s_mul_i32 s100, s64, 6
    s_sub_u32 s100, 13, s100
    s_lshl_b32 s100, s100, 14
    s_add_u32 m0, s49, 86016
    s_add_u32 s100, s100, s90
    buffer_load_dwordx4 v17, s[12:15], s100 offen lds
    v_add_f32_dpp v216, v216, v216 row_ror:1 row_mask:0xf bank_mask:0xf
    v_add_f32_dpp v217, v217, v217 row_ror:1 row_mask:0xf bank_mask:0xf
    v_add_f32_dpp v218, v218, v218 row_ror:1 row_mask:0xf bank_mask:0xf
    v_add_f32_dpp v219, v219, v219 row_ror:1 row_mask:0xf bank_mask:0xf
    v_cvt_pk_bf16_f32 v208, v216, v217
    v_cvt_pk_bf16_f32 v209, v218, v219
    ds_write_b64 v46, v[208:209] offset:256
    v_lshlrev_b32 v192, 16, v128
    v_and_b32 v193, 0xffff0000, v128
    v_lshlrev_b32 v194, 16, v129
    v_and_b32 v195, 0xffff0000, v129
    v_lshlrev_b32 v200, 16, v130
    v_and_b32 v201, 0xffff0000, v130
    v_lshlrev_b32 v202, 16, v131
    v_and_b32 v203, 0xffff0000, v131
    v_dot2c_f32_bf16 v192, s47, v136
    v_dot2c_f32_bf16 v193, s48, v136
    v_dot2c_f32_bf16 v194, s47, v137
    v_dot2c_f32_bf16 v195, s48, v137
    v_dot2c_f32_bf16 v200, s47, v138
    v_dot2c_f32_bf16 v201, s48, v138
    v_dot2c_f32_bf16 v202, s47, v139
    v_dot2c_f32_bf16 v203, s48, v139
    v_dot2c_f32_bf16 v192, s47, v144
    v_dot2c_f32_bf16 v193, s48, v144
    v_dot2c_f32_bf16 v194, s47, v145
    v_dot2c_f32_bf16 v195, s48, v145
    v_dot2c_f32_bf16 v200, s47, v146
    v_dot2c_f32_bf16 v201, s48, v146
    v_dot2c_f32_bf16 v202, s47, v147
    s_add_u32 s100, s98, 0
    s_and_b32 s100, s100, 3
    s_lshl_b32 s100, s100, 14
    s_add_u32 m0, s49, 98304
    s_add_u32 s100, s100, s91
    buffer_load_dwordx4 v17, s[36:39], s100 offen lds
    v_dot2c_f32_bf16 v203, s48, v147
    v_dot2c_f32_bf16 v192, s47, v152
    v_dot2c_f32_bf16 v193, s48, v152
    v_dot2c_f32_bf16 v194, s47, v153
    v_dot2c_f32_bf16 v195, s48, v153
    v_dot2c_f32_bf16 v200, s47, v154
    v_dot2c_f32_bf16 v201, s48, v154
    v_dot2c_f32_bf16 v202, s47, v155
    v_dot2c_f32_bf16 v203, s48, v155
    v_dot2c_f32_bf16 v192, s47, v160
    v_dot2c_f32_bf16 v193, s48, v160
    v_dot2c_f32_bf16 v194, s47, v161
    v_dot2c_f32_bf16 v195, s48, v161
    v_dot2c_f32_bf16 v200, s47, v162
    v_dot2c_f32_bf16 v201, s48, v162
    v_dot2c_f32_bf16 v202, s47, v163
    v_dot2c_f32_bf16 v203, s48, v163
    v_dot2c_f32_bf16 v192, s47, v168
    v_dot2c_f32_bf16 v193, s48, v168
    v_dot2c_f32_bf16 v194, s47, v169
    v_dot2c_f32_bf16 v195, s48, v169
    v_dot2c_f32_bf16 v200, s47, v170
    v_dot2c_f32_bf16 v201, s48, v170
    v_dot2c_f32_bf16 v202, s47, v171
    v_dot2c_f32_bf16 v203, s48, v171
    v_dot2c_f32_bf16 v192, s47, v176
    v_dot2c_f32_bf16 v193, s48, v176
    v_dot2c_f32_bf16 v194, s47, v177
    v_dot2c_f32_bf16 v195, s48, v177
    v_dot2c_f32_bf16 v200, s47, v178
    s_add_u32 s100, s98, 1
    s_and_b32 s100, s100, 3
    s_lshl_b32 s100, s100, 14
    s_add_u32 m0, s49, 102400
    s_add_u32 s100, s100, s91
    buffer_load_dwordx4 v17, s[36:39], s100 offen lds
    v_dot2c_f32_bf16 v201, s48, v178
    v_dot2c_f32_bf16 v202, s47, v179
    v_dot2c_f32_bf16 v203, s48, v179
    v_dot2c_f32_bf16 v192, s47, v184
    v_dot2c_f32_bf16 v193, s48, v184
    v_dot2c_f32_bf16 v194, s47, v185
    v_dot2c_f32_bf16 v195, s48, v185
    v_dot2c_f32_bf16 v200, s47, v186
    v_dot2c_f32_bf16 v201, s48, v186
    v_dot2c_f32_bf16 v202, s47, v187
    v_dot2c_f32_bf16 v203, s48, v187
    v_permlane32_swap_b32 v192, v200
    v_permlane32_swap_b32 v193, v201
    v_permlane32_swap_b32 v194, v202
    v_permlane32_swap_b32 v195, v203
    v_add_f32 v192, v192, v200
    v_add_f32 v193, v193, v201
    v_add_f32 v194, v194, v202
    v_add_f32 v195, v195, v203
    v_cvt_pk_bf16_f32 v192, v192, v193
    v_cvt_pk_bf16_f32 v193, v194, v195
    ds_write_b64 v47, v[192:193]
    v_and_b32 v44, 31, v1
    v_min_u32 v44, 16, v44
    v_and_b32 v45, 32, v1
    v_add_u32 v44, v44, v45
    v_lshlrev_b32 v44, 4, v44
    s_lshl_b32 s47, s52, 12
    s_add_u32 s47, s47, 147456
    v_add_u32 v44, s47, v44
    s_mov_b32 s57, 0
L_sp_3:
    s_waitcnt lgkmcnt(0)
    s_min_u32 s28, s28, s29
    s_min_u32 s30, s30, s31
    s_min_u32 s28, s28, s30
    s_cmp_ge_u32 s28, 1
    s_cbranch_scc1 L_sp_3_ok
    s_add_u32 s57, s57, 1
    s_cmp_gt_u32 s57, 32768
    s_cbranch_scc1 L_sp_3_ok
    s_sleep 1
    s_buffer_load_dwordx4 s[28:31], s[16:19], s44 offset:1024 glc
    s_branch L_sp_3
L_sp_3_ok:
    s_add_u32 s101, s98, 0
    s_and_b32 s101, s101, 3
    s_add_u32 s101, s101, s64
    s_lshl_b32 s101, s101, 10
    s_add_u32 s101, s101, s96
    buffer_load_dwordx4 v[132:135], v27, s[16:19], s101 offen sc1
    v_max3_f32 v60, v112, v113, v114
    v_max3_f32 v61, v115, v116, v117
    v_max3_f32 v60, v60, v118, v119
    v_max3_f32 v61, v61, v120, v121
    v_max3_f32 v60, v60, v122, v123
    v_max3_f32 v61, v61, v124, v125
    v_max3_f32 v60, v60, v126, v127
    v_max_f32 v60, v60, v61
    v_mul_f32 v60, v60, v25
    v_pk_fma_f32 v[112:113], v[112:113], v[24:25], v[60:61] op_sel:[0,1,0] op_sel_hi:[1,1,0] neg_lo:[0,0,1] neg_hi:[0,0,1]
    v_pk_fma_f32 v[114:115], v[114:115], v[24:25], v[60:61] op_sel:[0,1,0] op_sel_hi:[1,1,0] neg_lo:[0,0,1] neg_hi:[0,0,1]
    v_pk_fma_f32 v[116:117], v[116:117], v[24:25], v[60:61] op_sel:[0,1,0] op_sel_hi:[1,1,0] neg_lo:[0,0,1] neg_hi:[0,0,1]
    v_pk_fma_f32 v[118:119], v[118:119], v[24:25], v[60:61] op_sel:[0,1,0] op_sel_hi:[1,1,0] neg_lo:[0,0,1] neg_hi:[0,0,1]
    v_pk_fma_f32 v[120:121], v[120:121], v[24:25], v[60:61] op_sel:[0,1,0] op_sel_hi:[1,1,0] neg_lo:[0,0,1] neg_hi:[0,0,1]
    s_add_u32 s101, s98, 1
    s_and_b32 s101, s101, 3
    s_add_u32 s101, s101, s64
    s_lshl_b32 s101, s101, 10
    s_add_u32 s101, s101, s96
    buffer_load_dwordx4 v[140:143], v27, s[16:19], s101 offen sc1
    v_pk_fma_f32 v[122:123], v[122:123], v[24:25], v[60:61] op_sel:[0,1,0] op_sel_hi:[1,1,0] neg_lo:[0,0,1] neg_hi:[0,0,1]
    v_pk_fma_f32 v[124:125], v[124:125], v[24:25], v[60:61] op_sel:[0,1,0] op_sel_hi:[1,1,0] neg_lo:[0,0,1] neg_hi:[0,0,1]
    v_pk_fma_f32 v[126:127], v[126:127], v[24:25], v[60:61] op_sel:[0,1,0] op_sel_hi:[1,1,0] neg_lo:[0,0,1] neg_hi:[0,0,1]
    v_exp_f32 v112, v112
    v_exp_f32 v113, v113
    v_exp_f32 v114, v114
    v_exp_f32 v115, v115
    v_exp_f32 v116, v116
    v_exp_f32 v117, v117
    v_exp_f32 v118, v118
    v_exp_f32 v119, v119
    v_exp_f32 v120, v120
    v_exp_f32 v121, v121
    v_exp_f32 v122, v122
    v_exp_f32 v123, v123
    s_add_u32 s101, s98, 2
    s_and_b32 s101, s101, 3
    s_add_u32 s101, s101, s64
    s_lshl_b32 s101, s101, 10
    s_add_u32 s101, s101, s96
    buffer_load_dwordx4 v[148:151], v27, s[16:19], s101 offen sc1
    v_exp_f32 v124, v124
    v_exp_f32 v125, v125
    v_exp_f32 v126, v126
    v_exp_f32 v127, v127
    v_pk_add_f32 v[60:61], v[112:113], v[114:115]
    v_pk_add_f32 v[62:63], v[116:117], v[118:119]
    v_pk_add_f32 v[60:61], v[60:61], v[120:121]
    v_pk_add_f32 v[62:63], v[62:63], v[122:123]
    v_pk_add_f32 v[60:61], v[60:61], v[124:125]
    v_pk_add_f32 v[62:63], v[62:63], v[126:127]
    v_pk_add_f32 v[60:61], v[60:61], v[62:63]
    v_add_f32 v60, v60, v61
    v_rcp_f32 v60, v60
    s_nop 0
    v_pk_mul_f32 v[112:113], v[112:113], v[60:61] op_sel_hi:[1,0]
    s_add_u32 s101, s98, 3
    s_and_b32 s101, s101, 3
    s_add_u32 s101, s101, s64
    s_lshl_b32 s101, s101, 10
    s_add_u32 s101, s101, s96
    buffer_load_dwordx4 v[156:159], v27, s[16:19], s101 offen sc1
    v_pk_mul_f32 v[114:115], v[114:115], v[60:61] op_sel_hi:[1,0]
    v_pk_mul_f32 v[116:117], v[116:117], v[60:61] op_sel_hi:[1,0]
    v_pk_mul_f32 v[118:119], v[118:119], v[60:61] op_sel_hi:[1,0]
    v_pk_mul_f32 v[120:121], v[120:121], v[60:61] op_sel_hi:[1,0]
    v_pk_mul_f32 v[122:123], v[122:123], v[60:61] op_sel_hi:[1,0]
    v_pk_mul_f32 v[124:125], v[124:125], v[60:61] op_sel_hi:[1,0]
    v_pk_mul_f32 v[126:127], v[126:127], v[60:61] op_sel_hi:[1,0]
    v_cvt_pk_bf16_f32 v72, v112, v113
    v_cvt_pk_bf16_f32 v73, v114, v115
    v_cvt_pk_bf16_f32 v74, v116, v117
    v_cvt_pk_bf16_f32 v75, v118, v119
    v_cvt_pk_bf16_f32 v76, v120, v121
    v_cvt_pk_bf16_f32 v77, v122, v123
    v_cvt_pk_bf16_f32 v78, v124, v125
    v_cvt_pk_bf16_f32 v79, v126, v127
    s_waitcnt vmcnt(4) lgkmcnt(0)
    s_barrier
    ds_read_b128 v[128:131], v44 offset:0
    ds_read_b128 v[136:139], v44 offset:1024
    ds_read_b128 v[144:147], v44 offset:2048
    ds_read_b128 v[152:155], v44 offset:3072
    s_waitcnt lgkmcnt(3)
    v_mfma_f32_32x32x16_bf16 v[80:95], v[128:131], v[64:67], 0
    s_waitcnt lgkmcnt(1)
    v_mfma_f32_32x32x16_bf16 v[96:111], v[144:147], v[72:75], 0
    v_mfma_f32_32x32x16_bf16 v[80:95], v[136:139], v[68:71], v[80:95]
    s_waitcnt lgkmcnt(0)
    v_mfma_f32_32x32x16_bf16 v[96:111], v[152:155], v[76:79], v[96:111]
    s_buffer_load_dwordx4 s[28:31], s[16:19], s44 offset:1024 glc
    s_nop 8
    v_add_f32 v88, 0x358637bd, v88
    v_rcp_f32 v88, v88
    s_nop 0
    v_pk_mul_f32 v[80:81], v[80:81], v[88:89] op_sel_hi:[1,0]
    v_pk_mul_f32 v[82:83], v[82:83], v[88:89] op_sel_hi:[1,0]
    v_pk_mul_f32 v[84:85], v[84:85], v[88:89] op_sel_hi:[1,0]
    v_pk_mul_f32 v[86:87], v[86:87], v[88:89] op_sel_hi:[1,0]
    v_cvt_pk_bf16_f32 v44, v80, v81
    v_cvt_pk_bf16_f32 v45, v82, v83
    v_cvt_pk_bf16_f32 v46, v84, v85
    v_cvt_pk_bf16_f32 v47, v86, v87
    buffer_store_dwordx4 v[44:47], v27, s[16:19], s63 offen offset:0 sc1
    v_add_f32 v104, 0x358637bd, v104
    v_rcp_f32 v104, v104
    s_nop 0
    v_pk_mul_f32 v[96:97], v[96:97], v[104:105] op_sel_hi:[1,0]
    v_pk_mul_f32 v[98:99], v[98:99], v[104:105] op_sel_hi:[1,0]
    v_pk_mul_f32 v[100:101], v[100:101], v[104:105] op_sel_hi:[1,0]
    v_pk_mul_f32 v[102:103], v[102:103], v[104:105] op_sel_hi:[1,0]
    v_cvt_pk_bf16_f32 v48, v96, v97
    v_cvt_pk_bf16_f32 v49, v98, v99
    v_cvt_pk_bf16_f32 v50, v100, v101
    v_cvt_pk_bf16_f32 v51, v102, v103
    buffer_store_dwordx4 v[48:51], v27, s[16:19], s63 offen offset:1024 sc1
    v_bfe_u32 v52, v1, 2, 2
    v_lshrrev_b32 v53, 5, v1
    v_and_b32 v54, 63, v6
    s_lshl_b32 s47, s52, 5
    v_xor_b32 v54, s47, v54
    v_lshl_add_u32 v55, v53, 2, v52
    v_lshl_add_u32 v55, v55, 8, v54
    s_lshl_b32 s47, s52, 13
    v_add_u32 v55, s47, v55
    v_xor_b32 v52, s6, v52
    v_lshl_add_u32 v2, v52, 6, v55
    v_xor_b32 v3, 64, v2
    v_xor_b32 v4, 128, v2
    v_xor_b32 v5, 192, v2
    v_add_u32 v10, 131072, v2
    v_add_u32 v11, 131072, v3
    v_add_u32 v14, 131072, v4
    v_add_u32 v15, 131072, v5
    v_add_u32 v6, 65536, v2
    v_add_u32 v7, 65536, v3
    v_add_u32 v8, 65536, v4
    v_add_u32 v9, 65536, v5
    ds_read_b64_tr_b16 v[128:129], v10 offset:0
    ds_read_b64_tr_b16 v[130:131], v10 offset:2048
    ds_read_b64_tr_b16 v[136:137], v11 offset:0
    ds_read_b64_tr_b16 v[138:139], v11 offset:2048
    ds_read_b64_tr_b16 v[144:145], v14 offset:0
    ds_read_b64_tr_b16 v[146:147], v14 offset:2048
    ds_read_b64_tr_b16 v[152:153], v15 offset:0
    ds_read_b64_tr_b16 v[154:155], v15 offset:2048
    s_setprio 3
    s_waitcnt vmcnt(5) lgkmcnt(6)
    v_mfma_f32_32x32x16_bf16 v[64:79], v[128:131], v[132:135], 0
    ds_read_b64_tr_b16 v[160:161], v10 offset:4096
    ds_read_b64_tr_b16 v[162:163], v10 offset:6144
    s_add_u32 s100, s98, 2
    s_and_b32 s100, s100, 3
    s_lshl_b32 s100, s100, 14
    s_add_u32 m0, s49, 114688
    s_add_u32 s100, s100, s91
    buffer_load_dwordx4 v17, s[36:39], s100 offen lds
    s_waitcnt lgkmcnt(6)
    v_mfma_f32_32x32x16_bf16 v[80:95], v[136:139], v[132:135], 0
    ds_read_b64_tr_b16 v[168:169], v11 offset:4096
    ds_read_b64_tr_b16 v[170:171], v11 offset:6144
    s_add_u32 s100, s98, 3
    s_and_b32 s100, s100, 3
    s_lshl_b32 s100, s100, 14
    s_add_u32 m0, s49, 118784
    s_add_u32 s100, s100, s91
    buffer_load_dwordx4 v17, s[36:39], s100 offen lds
    s_waitcnt lgkmcnt(6)
    v_mfma_f32_32x32x16_bf16 v[96:111], v[144:147], v[132:135], 0
    ds_read_b64_tr_b16 v[176:177], v14 offset:4096
    ds_read_b64_tr_b16 v[178:179], v14 offset:6144
    s_mov_b32 s57, 0
L_sp_4:
    s_waitcnt lgkmcnt(0)
    s_min_u32 s28, s28, s29
    s_min_u32 s30, s30, s31
    s_min_u32 s28, s28, s30
    s_cmp_ge_u32 s28, 2
    s_cbranch_scc1 L_sp_4_ok
    s_add_u32 s57, s57, 1
    s_cmp_gt_u32 s57, 32768
    s_cbranch_scc1 L_sp_4_ok
    s_sleep 1
    s_buffer_load_dwordx4 s[28:31], s[16:19], s44 offset:1024 glc
    s_branch L_sp_4
L_sp_4_ok:
    s_add_u32 s101, s98, 4
    s_and_b32 s101, s101, 3
    s_add_u32 s101, s101, s64
    s_add_u32 s101, s101, 4
    s_lshl_b32 s101, s101, 10
    s_add_u32 s101, s101, s96
    buffer_load_dwordx4 v[164:167], v27, s[16:19], s101 offen sc1
    v_mfma_f32_32x32x16_bf16 v[112:127], v[152:155], v[132:135], 0
    ds_read_b64_tr_b16 v[184:185], v15 offset:4096
    ds_read_b64_tr_b16 v[186:187], v15 offset:6144
    s_add_u32 s101, s98, 5
    s_and_b32 s101, s101, 3
    s_add_u32 s101, s101, s64
    s_add_u32 s101, s101, 4
    s_lshl_b32 s101, s101, 10
    s_add_u32 s101, s101, s96
    buffer_load_dwordx4 v[172:175], v27, s[16:19], s101 offen sc1
    s_setprio 2
    s_waitcnt vmcnt(8)
    v_mfma_f32_32x32x16_bf16 v[64:79], v[160:163], v[140:143], v[64:79]
    ds_read_b64_tr_b16 v[128:129], v3 offset:49152
    ds_read_b64_tr_b16 v[130:131], v3 offset:51200
    s_add_u32 s101, s98, 6
    s_and_b32 s101, s101, 3
    s_add_u32 s101, s101, s64
    s_add_u32 s101, s101, 4
    s_lshl_b32 s101, s101, 10
    s_add_u32 s101, s101, s96
    buffer_load_dwordx4 v[180:183], v27, s[16:19], s101 offen sc1
    v_mfma_f32_32x32x16_bf16 v[80:95], v[168:171], v[140:143], v[80:95]
    ds_read_b64_tr_b16 v[136:137], v4 offset:49152
    ds_read_b64_tr_b16 v[138:139], v4 offset:51200
    s_add_u32 s101, s98, 7
    s_and_b32 s101, s101, 3
    s_add_u32 s101, s101, s64
    s_add_u32 s101, s101, 4
    s_lshl_b32 s101, s101, 10
    s_add_u32 s101, s101, s96
    buffer_load_dwordx4 v[188:191], v27, s[16:19], s101 offen sc1
    v_mfma_f32_32x32x16_bf16 v[96:111], v[176:179], v[140:143], v[96:111]
    ds_read_b64_tr_b16 v[144:145], v5 offset:49152
    ds_read_b64_tr_b16 v[146:147], v5 offset:51200
    s_waitcnt lgkmcnt(6)
    v_mfma_f32_32x32x16_bf16 v[112:127], v[184:187], v[140:143], v[112:127]
    ds_read_b64_tr_b16 v[152:153], v3 offset:53248
    ds_read_b64_tr_b16 v[154:155], v3 offset:55296
    s_setprio 1
    s_waitcnt vmcnt(9) lgkmcnt(6)
    v_mfma_f32_32x32x16_bf16 v[80:95], v[128:131], v[148:151], v[80:95]
    ds_read_b64_tr_b16 v[160:161], v4 offset:53248
    ds_read_b64_tr_b16 v[162:163], v4 offset:55296
    v_mov_b32 v13, 4
    buffer_store_dword v13, v12, s[16:19], s51 offen sc1
    s_waitcnt lgkmcnt(6)
    v_mfma_f32_32x32x16_bf16 v[96:111], v[136:139], v[148:151], v[96:111]
    ds_read_b64_tr_b16 v[168:169], v5 offset:53248
    ds_read_b64_tr_b16 v[170:171], v5 offset:55296
    v_and_b32 v61, 31, v1
    v_lshrrev_b32 v62, 5, v1
    v_lshlrev_b32 v62, 4, v62
    v_lshl_add_u32 v16, v61, 10, v62
    buffer_load_dwordx4 v[32:35], v16, s[8:11], s45 offen
    buffer_load_dwordx4 v[36:39], v62, s[92:95], s7 offen
    s_waitcnt lgkmcnt(6)
    v_mfma_f32_32x32x16_bf16 v[112:127], v[144:147], v[148:151], v[112:127]
    ds_read_b64_tr_b16 v[176:177], v3 offset:0
    ds_read_b64_tr_b16 v[178:179], v3 offset:2048
    s_waitcnt vmcnt(11) lgkmcnt(6)
    v_mfma_f32_32x32x16_bf16 v[80:95], v[152:155], v[156:159], v[80:95]
    ds_read_b64_tr_b16 v[184:185], v4 offset:0
    ds_read_b64_tr_b16 v[186:187], v4 offset:2048
    s_buffer_load_dwordx4 s[28:31], s[16:19], s44 offset:1024 glc
    s_setprio 0
    s_waitcnt lgkmcnt(6)
    v_mfma_f32_32x32x16_bf16 v[96:111], v[160:163], v[156:159], v[96:111]
    ds_read_b64_tr_b16 v[128:129], v5 offset:0
    ds_read_b64_tr_b16 v[130:131], v5 offset:2048
    s_waitcnt lgkmcnt(6)
    v_mfma_f32_32x32x16_bf16 v[112:127], v[168:171], v[156:159], v[112:127]
    ds_read_b64_tr_b16 v[136:137], v3 offset:4096
    ds_read_b64_tr_b16 v[138:139], v3 offset:6144
    s_waitcnt vmcnt(6) lgkmcnt(6)
    v_mfma_f32_32x32x16_bf16 v[80:95], v[176:179], v[164:167], v[80:95]
    ds_read_b64_tr_b16 v[144:145], v4 offset:4096
    ds_read_b64_tr_b16 v[146:147], v4 offset:6144
    s_waitcnt lgkmcnt(6)
    v_mfma_f32_32x32x16_bf16 v[96:111], v[184:187], v[164:167], v[96:111]
    ds_read_b64_tr_b16 v[152:153], v5 offset:4096
    ds_read_b64_tr_b16 v[154:155], v5 offset:6144
    s_mov_b32 s57, 0
L_sp_5:
    s_waitcnt lgkmcnt(0)
    s_min_u32 s28, s28, s29
    s_min_u32 s30, s30, s31
    s_min_u32 s28, s28, s30
    s_cmp_ge_u32 s28, 3
    s_cbranch_scc1 L_sp_5_ok
    s_add_u32 s57, s57, 1
    s_cmp_gt_u32 s57, 32768
    s_cbranch_scc1 L_sp_5_ok
    s_sleep 1
    s_buffer_load_dwordx4 s[28:31], s[16:19], s44 offset:1024 glc
    s_branch L_sp_5
L_sp_5_ok:
    s_add_u32 s101, s98, 8
    s_and_b32 s101, s101, 3
    s_add_u32 s101, s101, s64
    s_add_u32 s101, s101, 8
    s_lshl_b32 s101, s101, 10
    s_add_u32 s101, s101, s96
    buffer_load_dwordx4 v[196:199], v27, s[16:19], s101 offen sc1
    s_setprio 3
    v_mfma_f32_32x32x16_bf16 v[112:127], v[128:131], v[164:167], v[112:127]
    ds_read_b64_tr_b16 v[160:161], v3 offset:16384
    ds_read_b64_tr_b16 v[162:163], v3 offset:18432
    s_add_u32 s101, s98, 9
    s_and_b32 s101, s101, 3
    s_add_u32 s101, s101, s64
    s_add_u32 s101, s101, 8
    s_lshl_b32 s101, s101, 10
    s_add_u32 s101, s101, s96
    buffer_load_dwordx4 v[204:207], v27, s[16:19], s101 offen sc1
    s_waitcnt vmcnt(7)
    v_mfma_f32_32x32x16_bf16 v[80:95], v[136:139], v[172:175], v[80:95]
    ds_read_b64_tr_b16 v[168:169], v4 offset:16384
    ds_read_b64_tr_b16 v[170:171], v4 offset:18432
    s_add_u32 s101, s98, 10
    s_and_b32 s101, s101, 3
    s_add_u32 s101, s101, s64
    s_add_u32 s101, s101, 8
    s_lshl_b32 s101, s101, 10
    s_add_u32 s101, s101, s96
    buffer_load_dwordx4 v[212:215], v27, s[16:19], s101 offen sc1
    v_mfma_f32_32x32x16_bf16 v[96:111], v[144:147], v[172:175], v[96:111]
    ds_read_b64_tr_b16 v[176:177], v5 offset:16384
    ds_read_b64_tr_b16 v[178:179], v5 offset:18432
    s_add_u32 s101, s98, 11
    s_and_b32 s101, s101, 3
    s_add_u32 s101, s101, s64
    s_add_u32 s101, s101, 8
    s_lshl_b32 s101, s101, 10
    s_add_u32 s101, s101, s96
    buffer_load_dwordx4 v[220:223], v27, s[16:19], s101 offen sc1
    v_mfma_f32_32x32x16_bf16 v[112:127], v[152:155], v[172:175], v[112:127]
    ds_read_b64_tr_b16 v[184:185], v3 offset:20480
    ds_read_b64_tr_b16 v[186:187], v3 offset:22528
    s_mul_i32 s101, s64, 6
    s_sub_u32 s101, 12, s101
    s_lshl_b32 s101, s101, 10
    s_add_u32 s101, s101, s96
    buffer_load_dwordx4 v[228:231], v27, s[16:19], s101 offen sc1
    s_setprio 2
    s_waitcnt vmcnt(9) lgkmcnt(6)
    v_mfma_f32_32x32x16_bf16 v[80:95], v[160:163], v[180:183], v[80:95]
    ds_read_b64_tr_b16 v[128:129], v4 offset:20480
    ds_read_b64_tr_b16 v[130:131], v4 offset:22528
    s_mul_i32 s101, s64, 6
    s_sub_u32 s101, 13, s101
    s_lshl_b32 s101, s101, 10
    s_add_u32 s101, s101, s96
    buffer_load_dwordx4 v[236:239], v27, s[16:19], s101 offen sc1
    s_waitcnt lgkmcnt(6)
    v_mfma_f32_32x32x16_bf16 v[96:111], v[168:171], v[180:183], v[96:111]
    ds_read_b64_tr_b16 v[136:137], v5 offset:20480
    ds_read_b64_tr_b16 v[138:139], v5 offset:22528
    s_waitcnt lgkmcnt(6)
    v_mfma_f32_32x32x16_bf16 v[112:127], v[176:179], v[180:183], v[112:127]
    ds_read_b64_tr_b16 v[144:145], v3 offset:32768
    ds_read_b64_tr_b16 v[146:147], v3 offset:34816
    s_waitcnt vmcnt(9) lgkmcnt(6)
    v_mfma_f32_32x32x16_bf16 v[80:95], v[184:187], v[188:191], v[80:95]
    ds_read_b64_tr_b16 v[152:153], v4 offset:32768
    ds_read_b64_tr_b16 v[154:155], v4 offset:34816
    s_setprio 1
    s_waitcnt lgkmcnt(6)
    v_mfma_f32_32x32x16_bf16 v[96:111], v[128:131], v[188:191], v[96:111]
    ds_read_b64_tr_b16 v[160:161], v5 offset:32768
    ds_read_b64_tr_b16 v[162:163], v5 offset:34816
    s_add_u32 s101, s98, 0
    s_and_b32 s101, s101, 3
    s_lshl_b32 s101, s101, 10
    s_add_u32 s101, s101, s97
    buffer_load_dwordx4 v[244:247], v27, s[16:19], s101 offen sc1
    v_add_u32 v20, s46, v27
    v_xor_b32 v23, 8192, v20
    v_add_u32 v21, 65536, v20
    v_add_u32 v24, 65536, v23
    v_add_u32 v22, 131072, v20
    v_add_u32 v25, 131072, v23
    s_waitcnt lgkmcnt(6)
    v_mfma_f32_32x32x16_bf16 v[112:127], v[136:139], v[188:191], v[112:127]
    ds_read_b64_tr_b16 v[168:169], v3 offset:36864
    ds_read_b64_tr_b16 v[170:171], v3 offset:38912
    s_add_u32 s101, s98, 1
    s_and_b32 s101, s101, 3
    s_lshl_b32 s101, s101, 10
    s_add_u32 s101, s101, s97
    buffer_load_dwordx4 v[252:255], v27, s[16:19], s101 offen sc1
    s_waitcnt vmcnt(7) lgkmcnt(6)
    v_mfma_f32_32x32x16_bf16 v[80:95], v[144:147], v[196:199], v[80:95]
    ds_read_b64_tr_b16 v[176:177], v4 offset:36864
    ds_read_b64_tr_b16 v[178:179], v4 offset:38912
    s_add_u32 s101, s98, 2
    s_and_b32 s101, s101, 3
    s_lshl_b32 s101, s101, 10
    s_add_u32 s101, s101, s97
    buffer_load_dwordx4 v[132:135], v27, s[16:19], s101 offen sc1
    s_waitcnt lgkmcnt(6)
    v_mfma_f32_32x32x16_bf16 v[96:111], v[152:155], v[196:199], v[96:111]
    ds_read_b64_tr_b16 v[184:185], v5 offset:36864
    ds_read_b64_tr_b16 v[186:187], v5 offset:38912
    s_add_u32 s101, s98, 3
    s_and_b32 s101, s101, 3
    s_lshl_b32 s101, s101, 10
    s_add_u32 s101, s101, s97
    buffer_load_dwordx4 v[140:143], v27, s[16:19], s101 offen sc1
    s_setprio 0
    s_waitcnt lgkmcnt(6)
    v_mfma_f32_32x32x16_bf16 v[112:127], v[160:163], v[196:199], v[112:127]
    ds_read_b64_tr_b16 v[128:129], v7 offset:0
    ds_read_b64_tr_b16 v[130:131], v7 offset:2048
    s_waitcnt vmcnt(8) lgkmcnt(6)
    v_mfma_f32_32x32x16_bf16 v[80:95], v[168:171], v[204:207], v[80:95]
    ds_read_b64_tr_b16 v[136:137], v8 offset:0
    ds_read_b64_tr_b16 v[138:139], v8 offset:2048
    s_waitcnt lgkmcnt(6)
    v_mfma_f32_32x32x16_bf16 v[96:111], v[176:179], v[204:207], v[96:111]
    ds_read_b64_tr_b16 v[144:145], v9 offset:0
    ds_read_b64_tr_b16 v[146:147], v9 offset:2048
    s_waitcnt lgkmcnt(6)
    v_mfma_f32_32x32x16_bf16 v[112:127], v[184:187], v[204:207], v[112:127]
    ds_read_b64_tr_b16 v[152:153], v7 offset:4096
    ds_read_b64_tr_b16 v[154:155], v7 offset:6144
    s_setprio 3
    s_waitcnt vmcnt(7) lgkmcnt(6)
    v_mfma_f32_32x32x16_bf16 v[80:95], v[128:131], v[212:215], v[80:95]
    ds_read_b64_tr_b16 v[160:161], v8 offset:4096
    ds_read_b64_tr_b16 v[162:163], v8 offset:6144
    s_waitcnt lgkmcnt(6)
    v_mfma_f32_32x32x16_bf16 v[96:111], v[136:139], v[212:215], v[96:111]
    ds_read_b64_tr_b16 v[168:169], v9 offset:4096
    ds_read_b64_tr_b16 v[170:171], v9 offset:6144
    s_waitcnt lgkmcnt(6)
    v_mfma_f32_32x32x16_bf16 v[112:127], v[144:147], v[212:215], v[112:127]
    s_barrier
    ds_read_b64_tr_b16 v[176:177], v7 offset:16384
    ds_read_b64_tr_b16 v[178:179], v7 offset:18432
    s_waitcnt vmcnt(6) lgkmcnt(6)
    v_mfma_f32_32x32x16_bf16 v[80:95], v[152:155], v[220:223], v[80:95]
    ds_read_b64_tr_b16 v[184:185], v7 offset:20480
    ds_read_b64_tr_b16 v[186:187], v7 offset:22528
    s_setprio 2
    s_waitcnt lgkmcnt(6)
    v_mfma_f32_32x32x16_bf16 v[96:111], v[160:163], v[220:223], v[96:111]
    ds_read_b64_tr_b16 v[128:129], v7 offset:32768
    ds_read_b64_tr_b16 v[130:131], v7 offset:34816
    s_waitcnt lgkmcnt(6)
    v_mfma_f32_32x32x16_bf16 v[112:127], v[168:171], v[220:223], v[112:127]
    ds_read_b64_tr_b16 v[136:137], v7 offset:36864
    ds_read_b64_tr_b16 v[138:139], v7 offset:38912
    s_waitcnt vmcnt(5) lgkmcnt(6)
    v_mfma_f32_32x32x16_bf16 v[80:95], v[176:179], v[228:231], v[80:95]
    ds_read_b64_tr_b16 v[144:145], v7 offset:49152
    ds_read_b64_tr_b16 v[146:147], v7 offset:51200
    s_waitcnt vmcnt(3)
    v_max3_u32 v60, v244, v245, v246
    v_max_u32 v60, v60, v247
    v_cmp_eq_u32 vcc, -1, v60
    s_nop 0
    s_cbranch_vccnz L_v_6_slow
L_v_6_back:
    v_and_b32 v29, 3, v1
    v_lshlrev_b32 v29, 8, v29
    v_xor_b32 v29, s51, v29
    buffer_load_dword v28, v29, s[16:19], 0 offen sc1
    s_waitcnt lgkmcnt(6)
    v_mfma_f32_32x32x16_bf16 v[80:95], v[184:187], v[236:239], v[80:95]
    ds_read_b64_tr_b16 v[152:153], v7 offset:53248
    ds_read_b64_tr_b16 v[154:155], v7 offset:55296
    s_waitcnt vmcnt(3)
    v_max3_u32 v60, v252, v253, v254
    v_max_u32 v60, v60, v255
    v_cmp_eq_u32 vcc, -1, v60
    s_nop 0
    s_cbranch_vccnz L_v_7_slow
L_v_7_back:
    s_setprio 1
    s_waitcnt lgkmcnt(6)
    v_mfma_f32_32x32x16_bf16 v[80:95], v[128:131], v[244:247], v[80:95]
    ds_read_b64_tr_b16 v[160:161], v8 offset:16384
    ds_read_b64_tr_b16 v[162:163], v8 offset:18432
    s_waitcnt vmcnt(2)
    v_max3_u32 v60, v132, v133, v134
    v_max_u32 v60, v60, v135
    v_cmp_eq_u32 vcc, -1, v60
    s_nop 0
    s_cbranch_vccnz L_v_8_slow
L_v_8_back:
    v_lshlrev_b32 v52, 16, v32
    v_and_b32 v53, 0xffff0000, v32
    v_lshlrev_b32 v48, 16, v36
    v_and_b32 v49, 0xffff0000, v36
    v_add_f32 v52, v52, v48
    v_add_f32 v53, v53, v49
    s_waitcnt lgkmcnt(6)
    v_mfma_f32_32x32x16_bf16 v[80:95], v[136:139], v[252:255], v[80:95]
    ds_read_b64_tr_b16 v[168:169], v8 offset:20480
    ds_read_b64_tr_b16 v[170:171], v8 offset:22528
    s_waitcnt vmcnt(1)
    v_max3_u32 v60, v140, v141, v142
    v_max_u32 v60, v60, v143
    v_cmp_eq_u32 vcc, -1, v60
    s_nop 0
    s_cbranch_vccnz L_v_9_slow
L_v_9_back:
    v_lshlrev_b32 v54, 16, v33
    v_and_b32 v55, 0xffff0000, v33
    v_lshlrev_b32 v48, 16, v37
    v_and_b32 v49, 0xffff0000, v37
    v_add_f32 v54, v54, v48
    v_add_f32 v55, v55, v49
    s_waitcnt lgkmcnt(6)
    v_mfma_f32_32x32x16_bf16 v[80:95], v[144:147], v[132:135], v[80:95]
    ds_read_b64_tr_b16 v[176:177], v8 offset:32768
    ds_read_b64_tr_b16 v[178:179], v8 offset:34816
    v_lshlrev_b32 v56, 16, v34
    v_and_b32 v57, 0xffff0000, v34
    v_lshlrev_b32 v48, 16, v38
    v_and_b32 v49, 0xffff0000, v38
    v_add_f32 v56, v56, v48
    v_add_f32 v57, v57, v49
    s_waitcnt lgkmcnt(6)
    v_mfma_f32_32x32x16_bf16 v[80:95], v[152:155], v[140:143], v[80:95]
    ds_read_b64_tr_b16 v[184:185], v8 offset:36864
    ds_read_b64_tr_b16 v[186:187], v8 offset:38912
    v_lshlrev_b32 v58, 16, v35
    v_and_b32 v59, 0xffff0000, v35
    v_lshlrev_b32 v48, 16, v39
    v_and_b32 v49, 0xffff0000, v39
    v_add_f32 v58, v58, v48
    v_add_f32 v59, v59, v49
    s_setprio 0
    s_waitcnt lgkmcnt(6)
    v_mfma_f32_32x32x16_bf16 v[96:111], v[160:163], v[228:231], v[96:111]
    ds_read_b64_tr_b16 v[128:129], v8 offset:49152
    ds_read_b64_tr_b16 v[130:131], v8 offset:51200
    s_waitcnt lgkmcnt(6)
    v_mfma_f32_32x32x16_bf16 v[96:111], v[168:171], v[236:239], v[96:111]
    ds_read_b64_tr_b16 v[136:137], v8 offset:53248
    ds_read_b64_tr_b16 v[138:139], v8 offset:55296
    ds_write_b128 v22, v[88:91] offset:16384
    ds_write_b128 v22, v[92:95] offset:17408
    s_waitcnt lgkmcnt(8)
    v_mfma_f32_32x32x16_bf16 v[96:111], v[176:179], v[244:247], v[96:111]
    ds_read_b64_tr_b16 v[144:145], v9 offset:16384
    ds_read_b64_tr_b16 v[146:147], v9 offset:18432
    s_waitcnt lgkmcnt(2)
    s_barrier
    ds_read_b128 v[88:91], v25 offset:16384
    ds_read_b128 v[92:95], v25 offset:17408
    v_mfma_f32_32x32x16_bf16 v[96:111], v[184:187], v[252:255], v[96:111]
    ds_read_b64_tr_b16 v[152:153], v9 offset:20480
    ds_read_b64_tr_b16 v[154:155], v9 offset:22528
    s_setprio 3
    v_mfma_f32_32x32x16_bf16 v[96:111], v[128:131], v[132:135], v[96:111]
    ds_read_b64_tr_b16 v[160:161], v9 offset:32768
    ds_read_b64_tr_b16 v[162:163], v9 offset:34816
    s_waitcnt lgkmcnt(5)
    v_add_f32 v80, v80, v88
    v_add_f32 v81, v81, v89
    v_add_f32 v82, v82, v90
    v_add_f32 v83, v83, v91
    s_waitcnt lgkmcnt(4)
    v_add_f32 v84, v84, v92
    v_add_f32 v85, v85, v93
    v_add_f32 v86, v86, v94
    v_add_f32 v87, v87, v95
    v_cvt_pk_bf16_f32 v88, v80, v81
    v_cvt_pk_bf16_f32 v89, v82, v83
    v_cvt_pk_bf16_f32 v90, v84, v85
    v_cvt_pk_bf16_f32 v91, v86, v87
    s_xor_b32 s47, s2, 1
    s_mul_i32 s47, s47, 24576
    s_lshl_b32 s48, s3, 10
    s_add_u32 s47, s47, s48
    s_add_u32 s47, s47, 16777216
    buffer_store_dwordx4 v[88:91], v27, s[16:19], s47 offen sc1
    v_mfma_f32_32x32x16_bf16 v[96:111], v[136:139], v[140:143], v[96:111]
    ds_read_b64_tr_b16 v[168:169], v9 offset:36864
    ds_read_b64_tr_b16 v[170:171], v9 offset:38912
    v_mfma_f32_32x32x16_bf16 v[112:127], v[144:147], v[228:231], v[112:127]
    ds_read_b64_tr_b16 v[176:177], v9 offset:49152
    ds_read_b64_tr_b16 v[178:179], v9 offset:51200
    s_waitcnt lgkmcnt(6)
    v_mfma_f32_32x32x16_bf16 v[112:127], v[152:155], v[236:239], v[112:127]
    ds_read_b64_tr_b16 v[184:185], v9 offset:53248
    ds_read_b64_tr_b16 v[186:187], v9 offset:55296
    s_nop 2
    ds_write_b128 v22, v[104:107] offset:0
    ds_write_b128 v22, v[108:111] offset:1024
    s_setprio 2
    s_waitcnt lgkmcnt(8)
    v_mfma_f32_32x32x16_bf16 v[112:127], v[160:163], v[244:247], v[112:127]
    ds_read_b64_tr_b16 v[128:129], v2 offset:49152
    ds_read_b64_tr_b16 v[130:131], v2 offset:51200
    s_waitcnt lgkmcnt(2)
    s_barrier
    ds_read_b128 v[104:107], v25 offset:0
    ds_read_b128 v[108:111], v25 offset:1024
    v_mfma_f32_32x32x16_bf16 v[112:127], v[168:171], v[252:255], v[112:127]
    ds_read_b64_tr_b16 v[136:137], v2 offset:53248
    ds_read_b64_tr_b16 v[138:139], v2 offset:55296
    v_mfma_f32_32x32x16_bf16 v[112:127], v[176:179], v[132:135], v[112:127]
    ds_read_b64_tr_b16 v[144:145], v2 offset:0
    ds_read_b64_tr_b16 v[146:147], v2 offset:2048
    s_waitcnt lgkmcnt(5)
    v_add_f32 v96, v96, v104
    v_add_f32 v97, v97, v105
    v_add_f32 v98, v98, v106
    v_add_f32 v99, v99, v107
    s_waitcnt lgkmcnt(4)
    v_add_f32 v100, v100, v108
    v_add_f32 v101, v101, v109
    v_add_f32 v102, v102, v110
    v_add_f32 v103, v103, v111
    v_cvt_pk_bf16_f32 v104, v96, v97
    v_cvt_pk_bf16_f32 v105, v98, v99
    v_cvt_pk_bf16_f32 v106, v100, v101
    v_cvt_pk_bf16_f32 v107, v102, v103
    s_xor_b32 s47, s2, 2
    s_mul_i32 s47, s47, 24576
    s_lshl_b32 s48, s3, 10
    s_add_u32 s47, s47, s48
    s_add_u32 s47, s47, 16785408
    buffer_store_dwordx4 v[104:107], v27, s[16:19], s47 offen sc1
    v_mfma_f32_32x32x16_bf16 v[112:127], v[184:187], v[140:143], v[112:127]
    ds_read_b64_tr_b16 v[152:153], v2 offset:4096
    ds_read_b64_tr_b16 v[154:155], v2 offset:6144
    s_setprio 1
    v_mfma_f32_32x32x16_bf16 v[64:79], v[128:131], v[148:151], v[64:79]
    ds_read_b64_tr_b16 v[160:161], v2 offset:16384
    ds_read_b64_tr_b16 v[162:163], v2 offset:18432
    s_waitcnt lgkmcnt(6)
    v_mfma_f32_32x32x16_bf16 v[64:79], v[136:139], v[156:159], v[64:79]
    ds_read_b64_tr_b16 v[168:169], v2 offset:20480
    ds_read_b64_tr_b16 v[170:171], v2 offset:22528
    s_nop 1
    ds_write_b128 v22, v[120:123] offset:16384
    ds_write_b128 v22, v[124:127] offset:17408
    s_waitcnt lgkmcnt(8)
    v_mfma_f32_32x32x16_bf16 v[64:79], v[144:147], v[164:167], v[64:79]
    ds_read_b64_tr_b16 v[176:177], v2 offset:32768
    ds_read_b64_tr_b16 v[178:179], v2 offset:34816
    s_waitcnt lgkmcnt(2)
    s_barrier
    ds_read_b128 v[120:123], v25 offset:16384
    ds_read_b128 v[124:127], v25 offset:17408
    v_mfma_f32_32x32x16_bf16 v[64:79], v[152:155], v[172:175], v[64:79]
    ds_read_b64_tr_b16 v[184:185], v2 offset:36864
    ds_read_b64_tr_b16 v[186:187], v2 offset:38912
    s_setprio 0
    v_mfma_f32_32x32x16_bf16 v[64:79], v[160:163], v[180:183], v[64:79]
    ds_read_b64_tr_b16 v[128:129], v6 offset:0
    ds_read_b64_tr_b16 v[130:131], v6 offset:2048
    s_waitcnt lgkmcnt(5)
    v_add_f32 v112, v112, v120
    v_add_f32 v113, v113, v121
    v_add_f32 v114, v114, v122
    v_add_f32 v115, v115, v123
    s_waitcnt lgkmcnt(4)
    v_add_f32 v116, v116, v124
    v_add_f32 v117, v117, v125
    v_add_f32 v118, v118, v126
    v_add_f32 v119, v119, v127
    v_cvt_pk_bf16_f32 v120, v112, v113
    v_cvt_pk_bf16_f32 v121, v114, v115
    v_cvt_pk_bf16_f32 v122, v116, v117
    v_cvt_pk_bf16_f32 v123, v118, v119
    s_xor_b32 s47, s2, 3
    s_mul_i32 s47, s47, 24576
    s_lshl_b32 s48, s3, 10
    s_add_u32 s47, s47, s48
    s_add_u32 s47, s47, 16793600
    buffer_store_dwordx4 v[120:123], v27, s[16:19], s47 offen sc1
    v_mfma_f32_32x32x16_bf16 v[64:79], v[168:171], v[188:191], v[64:79]
    ds_read_b64_tr_b16 v[136:137], v6 offset:4096
    ds_read_b64_tr_b16 v[138:139], v6 offset:6144
    v_mfma_f32_32x32x16_bf16 v[64:79], v[176:179], v[196:199], v[64:79]
    ds_read_b64_tr_b16 v[144:145], v6 offset:16384
    ds_read_b64_tr_b16 v[146:147], v6 offset:18432
    s_waitcnt lgkmcnt(6)
    v_mfma_f32_32x32x16_bf16 v[64:79], v[184:187], v[204:207], v[64:79]
    ds_read_b64_tr_b16 v[152:153], v6 offset:20480
    ds_read_b64_tr_b16 v[154:155], v6 offset:22528
    s_setprio 3
    s_waitcnt lgkmcnt(6)
    v_mfma_f32_32x32x16_bf16 v[64:79], v[128:131], v[212:215], v[64:79]
    ds_read_b64_tr_b16 v[160:161], v6 offset:32768
    ds_read_b64_tr_b16 v[162:163], v6 offset:34816
    s_waitcnt lgkmcnt(6)
    v_mfma_f32_32x32x16_bf16 v[64:79], v[136:139], v[220:223], v[64:79]
    ds_read_b64_tr_b16 v[168:169], v6 offset:36864
    ds_read_b64_tr_b16 v[170:171], v6 offset:38912
    s_waitcnt lgkmcnt(6)
    v_mfma_f32_32x32x16_bf16 v[64:79], v[144:147], v[228:231], v[64:79]
    ds_read_b64_tr_b16 v[176:177], v6 offset:49152
    ds_read_b64_tr_b16 v[178:179], v6 offset:51200
    s_waitcnt lgkmcnt(6)
    v_mfma_f32_32x32x16_bf16 v[64:79], v[152:155], v[236:239], v[64:79]
    ds_read_b64_tr_b16 v[184:185], v6 offset:53248
    ds_read_b64_tr_b16 v[186:187], v6 offset:55296
    s_setprio 2
    s_waitcnt lgkmcnt(6)
    v_mfma_f32_32x32x16_bf16 v[64:79], v[160:163], v[244:247], v[64:79]
    s_waitcnt lgkmcnt(4)
    v_mfma_f32_32x32x16_bf16 v[64:79], v[168:171], v[252:255], v[64:79]
    s_waitcnt lgkmcnt(2)
    v_mfma_f32_32x32x16_bf16 v[64:79], v[176:179], v[132:135], v[64:79]
    s_waitcnt lgkmcnt(0)
    v_mfma_f32_32x32x16_bf16 v[64:79], v[184:187], v[140:143], v[64:79]
    s_setprio 0
    s_nop 10
    ds_write_b128 v22, v[72:75] offset:0
    ds_write_b128 v22, v[76:79] offset:1024
    s_waitcnt vmcnt(3)
    v_mov_b32 v28, v28
    s_mov_b32 s57, 0
L_pf_10:
    v_cmp_gt_u32 vcc, 4, v28
    s_add_u32 s57, s57, 1
    s_cbranch_vccz L_pf_10_ok
    s_cmp_gt_u32 s57, 32768
    s_cbranch_scc1 L_pf_10_ok
    s_sleep 1
    buffer_load_dword v28, v29, s[16:19], 0 offen sc1
    s_waitcnt vmcnt(0)
    s_branch L_pf_10
L_pf_10_ok:
    s_waitcnt lgkmcnt(0)
    s_barrier
    ds_read_b128 v[72:75], v25 offset:0
    ds_read_b128 v[76:79], v25 offset:1024
    s_mul_i32 s47, s2, 24576
    s_lshl_b32 s48, s3, 10
    s_add_u32 s47, s47, s48
    s_add_u32 s47, s47, 16777216
    buffer_load_dwordx4 v[192:195], v27, s[16:19], s47 offen sc1
    s_mul_i32 s47, s2, 24576
    s_lshl_b32 s48, s3, 10
    s_add_u32 s47, s47, s48
    s_add_u32 s47, s47, 16785408
    buffer_load_dwordx4 v[200:203], v27, s[16:19], s47 offen sc1
    s_mul_i32 s47, s2, 24576
    s_lshl_b32 s48, s3, 10
    s_add_u32 s47, s47, s48
    s_add_u32 s47, s47, 16793600
    buffer_load_dwordx4 v[208:211], v27, s[16:19], s47 offen sc1
    s_waitcnt lgkmcnt(1)
    v_pk_add_f32 v[64:65], v[64:65], v[72:73]
    v_pk_add_f32 v[66:67], v[66:67], v[74:75]
    s_waitcnt lgkmcnt(0)
    v_pk_add_f32 v[68:69], v[68:69], v[76:77]
    v_pk_add_f32 v[70:71], v[70:71], v[78:79]
    s_waitcnt vmcnt(2)
    v_max3_u32 v60, v192, v193, v194
    s_waitcnt vmcnt(1)
    v_max3_u32 v60, v60, v195, v200
    v_max3_u32 v60, v60, v201, v202
    s_waitcnt vmcnt(0)
    v_max3_u32 v60, v60, v203, v208
    v_max3_u32 v60, v60, v209, v210
    v_max_u32 v60, v60, v211
    v_cmp_eq_u32 vcc, -1, v60
    s_nop 0
    s_cbranch_vccnz L_v_11_slow
L_v_11_back:
    s_mov_b32 s47, 0x3f80
    s_mov_b32 s48, 0x3f800000
    v_dot2c_f32_bf16 v64, s47, v192
    v_dot2c_f32_bf16 v65, s48, v192
    v_dot2c_f32_bf16 v66, s47, v193
    v_dot2c_f32_bf16 v67, s48, v193
    v_dot2c_f32_bf16 v68, s47, v194
    v_dot2c_f32_bf16 v69, s48, v194
    v_dot2c_f32_bf16 v70, s47, v195
    v_dot2c_f32_bf16 v71, s48, v195
    v_dot2c_f32_bf16 v64, s47, v200
    v_dot2c_f32_bf16 v65, s48, v200
    v_dot2c_f32_bf16 v66, s47, v201
    v_dot2c_f32_bf16 v67, s48, v201
    v_dot2c_f32_bf16 v68, s47, v202
    v_dot2c_f32_bf16 v69, s48, v202
    v_dot2c_f32_bf16 v70, s47, v203
    v_dot2c_f32_bf16 v71, s48, v203
    v_dot2c_f32_bf16 v64, s47, v208
    v_dot2c_f32_bf16 v65, s48, v208
    v_dot2c_f32_bf16 v66, s47, v209
    v_dot2c_f32_bf16 v67, s48, v209
    v_dot2c_f32_bf16 v68, s47, v210
    v_dot2c_f32_bf16 v69, s48, v210
    v_dot2c_f32_bf16 v70, s47, v211
    v_dot2c_f32_bf16 v71, s48, v211
    v_permlane32_swap_b32 v64, v68
    v_permlane32_swap_b32 v65, v69
    v_permlane32_swap_b32 v66, v70
    v_permlane32_swap_b32 v67, v71
    v_pk_add_f32 v[52:53], v[52:53], v[64:65]
    v_pk_add_f32 v[54:55], v[54:55], v[66:67]
    v_pk_add_f32 v[56:57], v[56:57], v[68:69]
    v_pk_add_f32 v[58:59], v[58:59], v[70:71]
    v_cvt_pk_bf16_f32 v32, v52, v53
    v_cvt_pk_bf16_f32 v33, v54, v55
    v_cvt_pk_bf16_f32 v34, v56, v57
    v_cvt_pk_bf16_f32 v35, v58, v59
    buffer_store_dwordx4 v[32:35], v16, s[40:43], s45 offen
    s_endpgm
L_v_2_slow:
    s_mov_b32 s57, 0
L_v_2_loop:
    s_sleep 2
    buffer_load_dwordx4 v[208:211], v21, s[16:19], s65 offen offset:1024 sc1
    s_add_u32 s101, s4, 0
    s_and_b32 s101, s101, 7
    s_mul_i32 s101, s101, 4608
    s_add_u32 s101, s101, s65
    buffer_load_dwordx4 v[128:131], v20, s[16:19], s101 offen sc1
    s_add_u32 s101, s4, 1
    s_and_b32 s101, s101, 7
    s_mul_i32 s101, s101, 4608
    s_add_u32 s101, s101, s65
    buffer_load_dwordx4 v[136:139], v20, s[16:19], s101 offen sc1
    s_add_u32 s101, s4, 2
    s_and_b32 s101, s101, 7
    s_mul_i32 s101, s101, 4608
    s_add_u32 s101, s101, s65
    buffer_load_dwordx4 v[144:147], v20, s[16:19], s101 offen sc1
    s_add_u32 s101, s4, 3
    s_and_b32 s101, s101, 7
    s_mul_i32 s101, s101, 4608
    s_add_u32 s101, s101, s65
    buffer_load_dwordx4 v[152:155], v20, s[16:19], s101 offen sc1
    s_add_u32 s101, s4, 4
    s_and_b32 s101, s101, 7
    s_mul_i32 s101, s101, 4608
    s_add_u32 s101, s101, s65
    buffer_load_dwordx4 v[160:163], v20, s[16:19], s101 offen sc1
    s_add_u32 s101, s4, 5
    s_and_b32 s101, s101, 7
    s_mul_i32 s101, s101, 4608
    s_add_u32 s101, s101, s65
    buffer_load_dwordx4 v[168:171], v20, s[16:19], s101 offen sc1
    s_add_u32 s101, s4, 6
    s_and_b32 s101, s101, 7
    s_mul_i32 s101, s101, 4608
    s_add_u32 s101, s101, s65
    buffer_load_dwordx4 v[176:179], v20, s[16:19], s101 offen sc1
    s_add_u32 s101, s4, 7
    s_and_b32 s101, s101, 7
    s_mul_i32 s101, s101, 4608
    s_add_u32 s101, s101, s65
    buffer_load_dwordx4 v[184:187], v20, s[16:19], s101 offen sc1
    s_waitcnt vmcnt(0)
    v_max3_u32 v48, v208, v209, v210
    v_max3_u32 v48, v48, v211, v128
    v_max3_u32 v48, v48, v129, v130
    v_max3_u32 v48, v48, v131, v136
    v_max3_u32 v48, v48, v137, v138
    v_max3_u32 v48, v48, v139, v144
    v_max3_u32 v48, v48, v145, v146
    v_max3_u32 v48, v48, v147, v152
    v_max3_u32 v48, v48, v153, v154
    v_max3_u32 v48, v48, v155, v160
    v_max3_u32 v48, v48, v161, v162
    v_max3_u32 v48, v48, v163, v168
    v_max3_u32 v48, v48, v169, v170
    v_max3_u32 v48, v48, v171, v176
    v_max3_u32 v48, v48, v177, v178
    v_max3_u32 v48, v48, v179, v184
    v_max3_u32 v48, v48, v185, v186
    v_max_u32 v48, v48, v187
    v_cmp_eq_u32 vcc, -1, v48
    s_add_u32 s57, s57, 1
    s_cbranch_vccz L_v_2_back
    s_cmp_gt_u32 s57, 32768
    s_cbranch_scc0 L_v_2_loop
    s_branch L_v_2_back
L_v_6_slow:
    s_mov_b32 s57, 0
L_v_6_loop:
    s_sleep 2
    s_add_u32 s101, s98, 0
    s_and_b32 s101, s101, 3
    s_lshl_b32 s101, s101, 10
    s_add_u32 s101, s101, s97
    buffer_load_dwordx4 v[244:247], v27, s[16:19], s101 offen sc1
    s_waitcnt vmcnt(0)
    v_max3_u32 v60, v244, v245, v246
    v_max_u32 v60, v60, v247
    v_cmp_eq_u32 vcc, -1, v60
    s_add_u32 s57, s57, 1
    s_cbranch_vccz L_v_6_back
    s_cmp_gt_u32 s57, 32768
    s_cbranch_scc0 L_v_6_loop
    s_branch L_v_6_back
L_v_7_slow:
    s_mov_b32 s57, 0
L_v_7_loop:
    s_sleep 2
    s_add_u32 s101, s98, 1
    s_and_b32 s101, s101, 3
    s_lshl_b32 s101, s101, 10
    s_add_u32 s101, s101, s97
    buffer_load_dwordx4 v[252:255], v27, s[16:19], s101 offen sc1
    s_waitcnt vmcnt(0)
    v_max3_u32 v60, v252, v253, v254
    v_max_u32 v60, v60, v255
    v_cmp_eq_u32 vcc, -1, v60
    s_add_u32 s57, s57, 1
    s_cbranch_vccz L_v_7_back
    s_cmp_gt_u32 s57, 32768
    s_cbranch_scc0 L_v_7_loop
    s_branch L_v_7_back
L_v_8_slow:
    s_mov_b32 s57, 0
L_v_8_loop:
    s_sleep 2
    s_add_u32 s101, s98, 2
    s_and_b32 s101, s101, 3
    s_lshl_b32 s101, s101, 10
    s_add_u32 s101, s101, s97
    buffer_load_dwordx4 v[132:135], v27, s[16:19], s101 offen sc1
    s_waitcnt vmcnt(0)
    v_max3_u32 v60, v132, v133, v134
    v_max_u32 v60, v60, v135
    v_cmp_eq_u32 vcc, -1, v60
    s_add_u32 s57, s57, 1
    s_cbranch_vccz L_v_8_back
    s_cmp_gt_u32 s57, 32768
    s_cbranch_scc0 L_v_8_loop
    s_branch L_v_8_back
L_v_9_slow:
    s_mov_b32 s57, 0
L_v_9_loop:
    s_sleep 2
    s_add_u32 s101, s98, 3
    s_and_b32 s101, s101, 3
    s_lshl_b32 s101, s101, 10
    s_add_u32 s101, s101, s97
    buffer_load_dwordx4 v[140:143], v27, s[16:19], s101 offen sc1
    s_waitcnt vmcnt(0)
    v_max3_u32 v60, v140, v141, v142
    v_max_u32 v60, v60, v143
    v_cmp_eq_u32 vcc, -1, v60
    s_add_u32 s57, s57, 1
    s_cbranch_vccz L_v_9_back
    s_cmp_gt_u32 s57, 32768
    s_cbranch_scc0 L_v_9_loop
    s_branch L_v_9_back
L_v_11_slow:
    s_mov_b32 s57, 0
L_v_11_loop:
    s_sleep 2
    s_mul_i32 s47, s2, 24576
    s_lshl_b32 s48, s3, 10
    s_add_u32 s47, s47, s48
    s_add_u32 s47, s47, 16777216
    buffer_load_dwordx4 v[192:195], v27, s[16:19], s47 offen sc1
    s_mul_i32 s47, s2, 24576
    s_lshl_b32 s48, s3, 10
    s_add_u32 s47, s47, s48
    s_add_u32 s47, s47, 16785408
    buffer_load_dwordx4 v[200:203], v27, s[16:19], s47 offen sc1
    s_mul_i32 s47, s2, 24576
    s_lshl_b32 s48, s3, 10
    s_add_u32 s47, s47, s48
    s_add_u32 s47, s47, 16793600
    buffer_load_dwordx4 v[208:211], v27, s[16:19], s47 offen sc1
    s_waitcnt vmcnt(0)
    v_max3_u32 v60, v192, v193, v194
    v_max3_u32 v60, v60, v195, v200
    v_max3_u32 v60, v60, v201, v202
    v_max3_u32 v60, v60, v203, v208
    v_max3_u32 v60, v60, v209, v210
    v_max_u32 v60, v60, v211
    v_cmp_eq_u32 vcc, -1, v60
    s_add_u32 s57, s57, 1
    s_cbranch_vccz L_v_11_back
    s_cmp_gt_u32 s57, 32768
    s_cbranch_scc0 L_v_11_loop
    s_branch L_v_11_back
L_ffn:
    s_mov_b64 s[20:21], s[96:97]
    s_load_dwordx2 s[24:25], s[0:1], 48
    s_mov_b32 s22, 1835008
    s_mov_b32 s23, 0x20000
    v_mul_u32_u24 v16, 3584, v2
    v_add_u32 v16, v16, v4
    s_mul_i32 s47, s5, 448
    s_and_b32 s48, s5, 1
    s_lshl_b32 s56, s48, 6
    s_add_u32 s54, s47, s56
    s_mul_i32 s33, s3, 28672
    s_add_u32 s33, s33, s54
    v_add_u32 v22, s33, v16
    s_mul_i32 s101, s65, 1792
    s_add_u32 m0, s100, 65536
    s_add_u32 s65, s65, 128
    buffer_load_dwordx4 v22, s[20:23], s101 offen lds
    s_and_b32 s65, s65, 1023
    s_waitcnt lgkmcnt(0)
    s_mov_b32 s18, 25165824
    s_mov_b32 s19, 0x20000
    s_mov_b32 s30, 256
    s_mov_b32 s31, 0x20000
    s_mov_b32 s14, 1835008
    s_mov_b32 s15, 0x20000
    s_mov_b32 s38, 524288
    s_mov_b32 s39, 0x20000
    s_mov_b32 s42, 2097152
    s_mov_b32 s43, 0x20000
    s_mov_b32 s94, 1024
    s_mov_b32 s95, 0x20000
    s_mov_b32 s26, 3584
    s_mov_b32 s27, 0x20000
    v_lshlrev_b32 v27, 4, v1
    s_lshr_b32 s52, s3, 2
    s_and_b32 s58, s3, 3
    s_xor_b32 s49, s58, s52
    s_mov_b32 s57, 0x7f000000
    s_sub_u32 s47, s3, 2
    s_cmp_lt_u32 s47, 2
    s_cbranch_scc0 L_nwf
    v_mul_u32_u24 v3, 3584, v1
    s_mul_i32 s48, s34, 229376
    s_add_u32 s48, s48, s54
    s_lshl_b32 s56, s47, 7
    s_add_u32 s48, s48, s56
    s_add_u32 s48, s48, 128
    s_lshr_b32 s47, s47, 1
    s_and_b32 s47, s47, s5
    s_mul_i32 s47, s47, 448
    s_sub_u32 s48, s48, s47
    s_mov_b32 s57, s48
L_nwf:
    s_cmp_eq_u32 s3, 5
    s_cbranch_scc0 L_ncpf
    s_getpc_b64 s[60:61]
L_pcf:
    s_sub_u32 s60, s60, L_pcf-parallel_sum__linear_kernel_hedgehog__dense_activation_gelu__prompt_kernel
    s_subb_u32 s61, s61, 0
    s_lshr_b32 s47, s2, 3
    s_lshl_b32 s47, s47, 11
    v_and_b32 v3, 15, v1
    v_lshlrev_b32 v3, 7, v3
    v_add_u32 v3, s47, v3
    v_min_u32 v3, L_end-parallel_sum__linear_kernel_hedgehog__dense_activation_gelu__prompt_kernel, v3
    global_load_dword v253, v3, s[60:61]
L_ncpf:
    s_add_u32 m0, s46, 16384
    s_mul_i32 s101, s65, 1792
    buffer_load_dwordx4 v14, s[8:11], s65 offen lds
    buffer_load_dwordx4 v15, s[8:11], s65 offen offset:1024 lds
    s_add_u32 m0, s100, 73728
    s_add_u32 s65, s65, 128
    buffer_load_dwordx4 v22, s[20:23], s101 offen lds
    s_and_b32 s65, s65, 1023
    s_lshl_b32 s47, s4, 4
    s_add_u32 s47, s47, s5
    s_lshl_b32 s47, s47, 7
    s_and_b32 s48, s3, 2
    s_lshl_b32 s48, s48, 3
    s_add_u32 s47, s47, s48
    s_and_b32 s48, s3, 1
    s_lshl_b32 s48, s48, 2
    s_add_u32 s47, s47, s48
    s_lshl_b32 s48, s52, 3
    s_add_u32 s47, s47, s48
    s_add_u32 s51, s47, 12583936
    s_lshl_b32 s47, s4, 2
    s_add_u32 s47, s47, s58
    s_mul_i32 s53, s47, 147456
    v_and_b32 v5, 31, v1
    v_lshlrev_b32 v5, 1, v5
    s_lshl_b32 s47, s52, 6
    s_add_u32 s47, s47, s54
    buffer_load_ushort v40, v5, s[24:27], s47 offen offset:0
    buffer_load_ushort v41, v5, s[24:27], s47 offen offset:128
    buffer_load_ushort v42, v5, s[24:27], s47 offen offset:256
    s_lshl_b32 s47, s47, 5
    s_add_u32 s62, s53, s47
    s_mul_i32 s55, s5, 448
    s_add_u32 s47, s55, 384
    s_bitcmp1_b32 s5, 0
    s_cselect_b32 s55, s55, s47
    s_lshl_b32 s47, s52, 5
    v_xor_b32 v5, s47, v5
    buffer_load_ushort v43, v5, s[24:27], s55 offen
    s_add_u32 s47, s47, s55
    s_lshl_b32 s47, s47, 5
    s_add_u32 s63, s53, s47
    v_lshrrev_b32 v2, 2, v1
    v_and_b32 v4, 3, v1
    v_lshlrev_b32 v4, 4, v4
    v_mul_u32_u24 v18, 3584, v2
    v_add_u32 v18, v18, v4
    s_mul_i32 s47, s58, 57344
    s_add_u32 s54, s54, s47
    v_add_u32 v16, s54, v16
    s_add_u32 s55, s55, s47
    v_add_u32 v18, s55, v18
    s_add_u32 s47, s34, s52
    s_add_u32 s48, s47, 0
    s_and_b32 s48, s48, 7
    s_mul_i32 s32, s48, 229376
    s_add_u32 s48, s47, 2
    s_and_b32 s48, s48, 7
    s_mul_i32 s33, s48, 229376
    s_add_u32 s48, s47, 4
    s_and_b32 s48, s48, 7
    s_mul_i32 s34, s48, 229376
    s_add_u32 s48, s47, 6
    s_and_b32 s48, s48, 7
    s_mul_i32 s35, s48, 229376
    s_mov_b32 s59, 0x3b000000
    s_mov_b32 s50, 0x3f803f80
    v_bfe_u32 v44, v1, 2, 2
    v_lshrrev_b32 v45, 5, v1
    v_bfe_u32 v46, v1, 4, 1
    v_lshlrev_b32 v46, 5, v46
    v_and_b32 v47, 3, v1
    v_lshl_add_u32 v46, v47, 3, v46
    v_and_b32 v48, 31, v1
    v_bfe_u32 v49, v1, 1, 3
    v_xor_b32 v49, v49, v45
    s_lshl_b32 s47, s58, 12
    v_lshlrev_b32 v52, 7, v48
    v_add_u32 v52, s47, v52
    v_lshl_add_u32 v53, v45, 3, v44
    v_lshl_add_u32 v54, v53, 7, v46
    v_lshrrev_b32 v51, 1, v44
    v_xor_b32 v51, s52, v51
    v_lshl_add_u32 v54, v51, 6, v54
    s_xor_b32 s47, s49, 0
    s_lshl_b32 s48, s47, 1
    v_xor_b32 v50, s48, v49
    v_lshl_add_u32 v2, v50, 4, v52
    s_lshl_b32 s48, s47, 11
    s_add_u32 s48, s48, 65536
    v_add_u32 v6, s48, v54
    s_xor_b32 s47, s49, 1
    s_lshl_b32 s48, s47, 1
    v_xor_b32 v50, s48, v49
    v_lshl_add_u32 v3, v50, 4, v52
    s_lshl_b32 s48, s47, 11
    s_add_u32 s48, s48, 65536
    v_add_u32 v7, s48, v54
    s_xor_b32 s47, s49, 2
    s_lshl_b32 s48, s47, 1
    v_xor_b32 v50, s48, v49
    v_lshl_add_u32 v4, v50, 4, v52
    s_lshl_b32 s48, s47, 11
    s_add_u32 s48, s48, 65536
    v_add_u32 v8, s48, v54
    s_xor_b32 s47, s49, 3
    s_lshl_b32 s48, s47, 1
    v_xor_b32 v50, s48, v49
    v_lshl_add_u32 v5, v50, 4, v52
    s_lshl_b32 s48, s47, 11
    s_add_u32 s48, s48, 65536
    v_add_u32 v9, s48, v54
    s_lshl_b32 s47, s52, 5
    v_xor_b32 v51, s47, v46
    v_lshl_add_u32 v51, v53, 6, v51
    s_xor_b32 s47, s49, 0
    s_lshl_b32 s47, s47, 10
    v_add_u32 v10, s47, v51
    s_xor_b32 s47, s49, 2
    s_lshl_b32 s47, s47, 10
    v_add_u32 v11, s47, v51
    v_lshlrev_b32 v48, 4, v48
    s_lshl_b32 s47, s52, 9
    s_add_u32 s47, s47, 155648
    v_add_u32 v0, s47, v48
    s_lshl_b32 s47, s58, 9
    s_add_u32 s47, s47, 159744
    v_add_u32 v19, s47, v48
    v_lshrrev_b32 v48, 2, v1
    v_xor_b32 v48, v48, v1
    v_and_b32 v48, 4, v48
    v_cmp_eq_u32 vcc, 0, v48
    v_mov_b32 v48, s50
    v_mov_b32 v120, -1
    v_mov_b32 v121, -1
    v_mov_b32 v122, -1
    v_mov_b32 v123, -1
    v_mov_b32 v12, 0
    v_mov_b32 v31, 0
    v_mov_b32 v34, 0
    v_mov_b32 v35, 0
    v_cndmask_b32 v36, 0, v48, vcc
    v_cndmask_b32 v37, 0, v48, vcc
    v_cndmask_b32 v38, 0, v48, vcc
    v_cndmask_b32 v39, 0, v48, vcc
    s_lshl_b32 s58, s58, 2
    v_lshrrev_b32 v44, 4, v1
    v_lshlrev_b32 v45, 2, v44
    v_and_b32 v46, 15, v1
    v_xor_b32 v46, v46, v45
    v_lshlrev_b32 v46, 4, v46
    v_lshl_add_u32 v17, v44, 10, v46
    s_lshl_b32 s56, s6, 1
    s_add_u32 s56, s56, s52
    s_lshl_b32 s47, s7, 8
    s_lshl_b32 s48, s58, 10
    s_add_u32 s48, s48, s47
    s_mul_i32 s90, s56, 229376
    s_add_u32 s90, s90, s48
    s_lshl_b32 s91, s56, 16
    s_add_u32 s91, s91, s48
    s_mul_i32 s96, s56, 14336
    s_add_u32 s96, s96, s53
    s_lshl_b32 s97, s56, 12
    s_add_u32 s97, s97, s53
    s_add_u32 s97, s97, 114688
    s_lshl_b32 s48, s4, 4
    s_add_u32 s48, s48, s56
    s_lshl_b32 s48, s48, 7
    s_and_b32 s44, s3, 2
    s_lshl_b32 s44, s44, 3
    s_add_u32 s44, s44, s48
    s_add_u32 s44, s44, 12582912
    s_mul_i32 s98, s7, 5
    s_lshr_b32 s98, s98, 1
    s_add_u32 s98, s98, s4
    s_and_b32 s98, s98, 7
    s_lshl_b32 s56, s56, 5
    s_add_u32 s7, s47, s56
    s_lshl_b32 s45, s4, 17
    s_lshl_b32 s48, s58, 13
    s_add_u32 s45, s45, s48
    s_add_u32 s45, s45, s7
    s_and_b32 s99, s3, 1
    s_lshl_b32 s99, s99, 1
    s_lshl_b32 s64, s52, 1
    s_lshl_b32 s49, s52, 13
    s_lshl_b32 s48, s58, 8
    s_add_u32 s49, s49, s48
    s_waitcnt vmcnt(7)
    s_barrier
    ds_read_b128 v[128:131], v2 offset:0
    ds_read_b64_tr_b16 v[64:65], v6 offset:0
    ds_read_b64_tr_b16 v[66:67], v6 offset:512
    ds_read_b128 v[132:135], v3 offset:0
    ds_read_b64_tr_b16 v[68:69], v7 offset:0
    ds_read_b64_tr_b16 v[70:71], v7 offset:512
    s_setprio 1
    s_waitcnt lgkmcnt(3)
    v_mfma_f32_32x32x16_bf16 v[80:95], v[64:67], v[128:131], 0
    ds_read_b128 v[136:139], v4 offset:0
    ds_read_b64_tr_b16 v[72:73], v8 offset:0
    ds_read_b64_tr_b16 v[74:75], v8 offset:512
    v_mfma_f32_4x4x4_16b_bf16 v[52:55], v[128:129], v[128:129], 0
    v_mfma_f32_4x4x4_16b_bf16 v[60:63], v[130:131], v[130:131], 0
    v_mfma_f32_16x16x32_bf16 v[48:51], v[36:39], v[128:131], 0
    v_mfma_f32_16x16x32_bf16 v[112:115], v[36:39], v[64:67], 0
    s_add_u32 m0, s46, 32768
    s_mul_i32 s101, s65, 1792
    buffer_load_dwordx4 v14, s[8:11], s65 offen lds
    buffer_load_dwordx4 v15, s[8:11], s65 offen offset:1024 lds
    s_add_u32 m0, s100, 81920
    s_add_u32 s65, s65, 128
    buffer_load_dwordx4 v22, s[20:23], s101 offen lds
    s_and_b32 s65, s65, 1023
    s_setprio 0
    s_waitcnt lgkmcnt(3)
    v_mfma_f32_32x32x16_bf16 v[80:95], v[68:71], v[132:135], v[80:95]
    ds_read_b128 v[140:143], v5 offset:0
    ds_read_b64_tr_b16 v[76:77], v9 offset:0
    ds_read_b64_tr_b16 v[78:79], v9 offset:512
    s_waitcnt lgkmcnt(5)
    v_mfma_f32_4x4x4_16b_bf16 v[52:55], v[136:137], v[136:137], v[52:55]
    v_mfma_f32_4x4x4_16b_bf16 v[60:63], v[138:139], v[138:139], v[60:63]
    v_mfma_f32_16x16x32_bf16 v[48:51], v[36:39], v[136:139], v[48:51]
    s_waitcnt vmcnt(7)
    s_barrier
    s_setprio 3
    s_waitcnt lgkmcnt(3)
    v_mfma_f32_32x32x16_bf16 v[80:95], v[72:75], v[136:139], v[80:95]
    ds_read_b128 v[144:147], v2 offset:16384
    ds_read_b64_tr_b16 v[64:65], v6 offset:8192
    ds_read_b64_tr_b16 v[66:67], v6 offset:8704
    s_add_u32 m0, s46, 49152
    s_mul_i32 s101, s65, 1792
    buffer_load_dwordx4 v14, s[8:11], s65 offen lds
    s_setprio 2
    s_waitcnt lgkmcnt(3)
    v_mfma_f32_32x32x16_bf16 v[80:95], v[76:79], v[140:143], v[80:95]
    ds_read_b128 v[148:151], v3 offset:16384
    ds_read_b64_tr_b16 v[68:69], v7 offset:8192
    ds_read_b64_tr_b16 v[70:71], v7 offset:8704
    s_waitcnt lgkmcnt(5)
    v_mfma_f32_4x4x4_16b_bf16 v[52:55], v[144:145], v[144:145], v[52:55]
    v_mfma_f32_4x4x4_16b_bf16 v[60:63], v[146:147], v[146:147], v[60:63]
    v_mfma_f32_16x16x32_bf16 v[48:51], v[36:39], v[144:147], v[48:51]
    buffer_load_dwordx4 v15, s[8:11], s65 offen offset:1024 lds
    s_setprio 1
    s_waitcnt lgkmcnt(3)
    v_mfma_f32_32x32x16_bf16 v[80:95], v[64:67], v[144:147], v[80:95]
    ds_read_b128 v[152:155], v4 offset:16384
    ds_read_b64_tr_b16 v[72:73], v8 offset:8192
    ds_read_b64_tr_b16 v[74:75], v8 offset:8704
    v_mfma_f32_16x16x32_bf16 v[112:115], v[36:39], v[64:67], v[112:115]
    s_add_u32 m0, s100, 90112
    s_add_u32 s65, s65, 128
    buffer_load_dwordx4 v22, s[20:23], s101 offen lds
    s_and_b32 s65, s65, 1023
    s_setprio 0
    s_waitcnt lgkmcnt(3)
    v_mfma_f32_32x32x16_bf16 v[80:95], v[68:71], v[148:151], v[80:95]
    ds_read_b128 v[156:159], v5 offset:16384
    ds_read_b64_tr_b16 v[76:77], v9 offset:8192
    ds_read_b64_tr_b16 v[78:79], v9 offset:8704
    s_waitcnt lgkmcnt(5)
    v_mfma_f32_4x4x4_16b_bf16 v[52:55], v[152:153], v[152:153], v[52:55]
    v_mfma_f32_4x4x4_16b_bf16 v[60:63], v[154:155], v[154:155], v[60:63]
    v_mfma_f32_16x16x32_bf16 v[48:51], v[36:39], v[152:155], v[48:51]
    v_mul_u32_u24 v45, 3584, v1
    buffer_load_dword v46, v45, s[20:23], s57 offen
    s_waitcnt vmcnt(4)
    s_barrier
    s_setprio 3
    s_waitcnt lgkmcnt(3)
    v_mfma_f32_32x32x16_bf16 v[80:95], v[72:75], v[152:155], v[80:95]
    ds_read_b128 v[160:163], v2 offset:32768
    ds_read_b64_tr_b16 v[64:65], v6 offset:16384
    ds_read_b64_tr_b16 v[66:67], v6 offset:16896
    s_add_u32 m0, s46, 0
    s_mul_i32 s101, s65, 1792
    buffer_load_dwordx4 v14, s[8:11], s65 offen lds
    s_setprio 2
    s_waitcnt lgkmcnt(3)
    v_mfma_f32_32x32x16_bf16 v[80:95], v[76:79], v[156:159], v[80:95]
    ds_read_b128 v[164:167], v3 offset:32768
    ds_read_b64_tr_b16 v[68:69], v7 offset:16384
    ds_read_b64_tr_b16 v[70:71], v7 offset:16896
    s_waitcnt lgkmcnt(5)
    v_mfma_f32_4x4x4_16b_bf16 v[52:55], v[160:161], v[160:161], v[52:55]
    v_mfma_f32_4x4x4_16b_bf16 v[60:63], v[162:163], v[162:163], v[60:63]
    v_mfma_f32_16x16x32_bf16 v[48:51], v[36:39], v[160:163], v[48:51]
    buffer_load_dwordx4 v15, s[8:11], s65 offen offset:1024 lds
    s_setprio 1
    s_waitcnt lgkmcnt(3)
    v_mfma_f32_32x32x16_bf16 v[80:95], v[64:67], v[160:163], v[80:95]
    ds_read_b128 v[168:171], v4 offset:32768
    ds_read_b64_tr_b16 v[72:73], v8 offset:16384
    ds_read_b64_tr_b16 v[74:75], v8 offset:16896
    v_mfma_f32_16x16x32_bf16 v[112:115], v[36:39], v[64:67], v[112:115]
    s_add_u32 m0, s100, 98304
    s_add_u32 s65, s65, 128
    buffer_load_dwordx4 v22, s[20:23], s101 offen lds
    s_and_b32 s65, s65, 1023
    s_setprio 0
    s_waitcnt lgkmcnt(3)
    v_mfma_f32_32x32x16_bf16 v[80:95], v[68:71], v[164:167], v[80:95]
    ds_read_b128 v[172:175], v5 offset:32768
    ds_read_b64_tr_b16 v[76:77], v9 offset:16384
    ds_read_b64_tr_b16 v[78:79], v9 offset:16896
    s_waitcnt lgkmcnt(5)
    v_mfma_f32_4x4x4_16b_bf16 v[52:55], v[168:169], v[168:169], v[52:55]
    v_mfma_f32_4x4x4_16b_bf16 v[60:63], v[170:171], v[170:171], v[60:63]
    v_mfma_f32_16x16x32_bf16 v[48:51], v[36:39], v[168:171], v[48:51]
    s_waitcnt vmcnt(4)
    s_barrier
    s_setprio 3
    s_waitcnt lgkmcnt(3)
    v_mfma_f32_32x32x16_bf16 v[80:95], v[72:75], v[168:171], v[80:95]
    ds_read_b128 v[176:179], v2 offset:49152
    ds_read_b64_tr_b16 v[64:65], v6 offset:24576
    ds_read_b64_tr_b16 v[66:67], v6 offset:25088
    s_add_u32 m0, s46, 16384
    s_mul_i32 s101, s65, 1792
    buffer_load_dwordx4 v14, s[8:11], s65 offen lds
    s_setprio 2
    s_waitcnt lgkmcnt(3)
    v_mfma_f32_32x32x16_bf16 v[80:95], v[76:79], v[172:175], v[80:95]
    ds_read_b128 v[180:183], v3 offset:49152
    ds_read_b64_tr_b16 v[68:69], v7 offset:24576
    ds_read_b64_tr_b16 v[70:71], v7 offset:25088
    s_waitcnt lgkmcnt(5)
    v_mfma_f32_4x4x4_16b_bf16 v[52:55], v[176:177], v[176:177], v[52:55]
    v_mfma_f32_4x4x4_16b_bf16 v[60:63], v[178:179], v[178:179], v[60:63]
    v_mfma_f32_16x16x32_bf16 v[48:51], v[36:39], v[176:179], v[48:51]
    buffer_load_dwordx4 v15, s[8:11], s65 offen offset:1024 lds
    s_setprio 1
    s_waitcnt lgkmcnt(3)
    v_mfma_f32_32x32x16_bf16 v[80:95], v[64:67], v[176:179], v[80:95]
    ds_read_b128 v[184:187], v4 offset:49152
    ds_read_b64_tr_b16 v[72:73], v8 offset:24576
    ds_read_b64_tr_b16 v[74:75], v8 offset:25088
    v_mfma_f32_16x16x32_bf16 v[112:115], v[36:39], v[64:67], v[112:115]
    s_add_u32 m0, s100, 106496
    s_add_u32 s65, s65, 128
    buffer_load_dwordx4 v22, s[20:23], s101 offen lds
    s_and_b32 s65, s65, 1023
    s_setprio 0
    s_waitcnt lgkmcnt(3)
    v_mfma_f32_32x32x16_bf16 v[80:95], v[68:71], v[180:183], v[80:95]
    ds_read_b128 v[188:191], v5 offset:49152
    ds_read_b64_tr_b16 v[76:77], v9 offset:24576
    ds_read_b64_tr_b16 v[78:79], v9 offset:25088
    s_waitcnt lgkmcnt(5)
    v_mfma_f32_4x4x4_16b_bf16 v[52:55], v[184:185], v[184:185], v[52:55]
    v_mfma_f32_4x4x4_16b_bf16 v[60:63], v[186:187], v[186:187], v[60:63]
    v_mfma_f32_16x16x32_bf16 v[48:51], v[36:39], v[184:187], v[48:51]
    s_waitcnt vmcnt(3)
    s_barrier
    s_setprio 3
    s_waitcnt lgkmcnt(3)
    v_mfma_f32_32x32x16_bf16 v[80:95], v[72:75], v[184:187], v[80:95]
    ds_read_b128 v[192:195], v2 offset:0
    ds_read_b64_tr_b16 v[64:65], v6 offset:32768
    ds_read_b64_tr_b16 v[66:67], v6 offset:33280
    s_add_u32 m0, s46, 32768
    s_mul_i32 s101, s65, 1792
    buffer_load_dwordx4 v14, s[8:11], s65 offen lds
    s_setprio 2
    s_waitcnt lgkmcnt(3)
    v_mfma_f32_32x32x16_bf16 v[80:95], v[76:79], v[188:191], v[80:95]
    ds_read_b128 v[196:199], v3 offset:0
    ds_read_b64_tr_b16 v[68:69], v7 offset:32768
    ds_read_b64_tr_b16 v[70:71], v7 offset:33280
    s_waitcnt lgkmcnt(5)
    v_mfma_f32_4x4x4_16b_bf16 v[52:55], v[192:193], v[192:193], v[52:55]
    v_mfma_f32_4x4x4_16b_bf16 v[60:63], v[194:195], v[194:195], v[60:63]
    v_mfma_f32_16x16x32_bf16 v[48:51], v[36:39], v[192:195], v[48:51]
    buffer_load_dwordx4 v15, s[8:11], s65 offen offset:1024 lds
    s_setprio 1
    s_waitcnt lgkmcnt(3)
    v_mfma_f32_32x32x16_bf16 v[80:95], v[64:67], v[192:195], v[80:95]
    ds_read_b128 v[200:203], v4 offset:0
    ds_read_b64_tr_b16 v[72:73], v8 offset:32768
    ds_read_b64_tr_b16 v[74:75], v8 offset:33280
    v_mfma_f32_16x16x32_bf16 v[112:115], v[36:39], v[64:67], v[112:115]
    s_add_u32 m0, s100, 114688
    s_add_u32 s65, s65, 128
    buffer_load_dwordx4 v22, s[20:23], s101 offen lds
    s_and_b32 s65, s65, 1023
    s_setprio 0
    s_waitcnt lgkmcnt(3)
    v_mfma_f32_32x32x16_bf16 v[80:95], v[68:71], v[196:199], v[80:95]
    ds_read_b128 v[204:207], v5 offset:0
    ds_read_b64_tr_b16 v[76:77], v9 offset:32768
    ds_read_b64_tr_b16 v[78:79], v9 offset:33280
    s_waitcnt lgkmcnt(5)
    v_mfma_f32_4x4x4_16b_bf16 v[52:55], v[200:201], v[200:201], v[52:55]
    v_mfma_f32_4x4x4_16b_bf16 v[60:63], v[202:203], v[202:203], v[60:63]
    v_mfma_f32_16x16x32_bf16 v[48:51], v[36:39], v[200:203], v[48:51]
    s_waitcnt vmcnt(3)
    s_barrier
    s_setprio 3
    s_waitcnt lgkmcnt(3)
    v_mfma_f32_32x32x16_bf16 v[80:95], v[72:75], v[200:203], v[80:95]
    ds_read_b128 v[208:211], v2 offset:16384
    ds_read_b64_tr_b16 v[64:65], v6 offset:40960
    ds_read_b64_tr_b16 v[66:67], v6 offset:41472
    s_add_u32 m0, s46, 49152
    s_mul_i32 s101, s65, 1792
    buffer_load_dwordx4 v14, s[8:11], s65 offen lds
    s_setprio 2
    s_waitcnt lgkmcnt(3)
    v_mfma_f32_32x32x16_bf16 v[80:95], v[76:79], v[204:207], v[80:95]
    ds_read_b128 v[212:215], v3 offset:16384
    ds_read_b64_tr_b16 v[68:69], v7 offset:40960
    ds_read_b64_tr_b16 v[70:71], v7 offset:41472
    s_waitcnt lgkmcnt(5)
    v_mfma_f32_4x4x4_16b_bf16 v[52:55], v[208:209], v[208:209], v[52:55]
    v_mfma_f32_4x4x4_16b_bf16 v[60:63], v[210:211], v[210:211], v[60:63]
    v_mfma_f32_16x16x32_bf16 v[48:51], v[36:39], v[208:211], v[48:51]
    buffer_load_dwordx4 v15, s[8:11], s65 offen offset:1024 lds
    s_setprio 1
    s_waitcnt lgkmcnt(3)
    v_mfma_f32_32x32x16_bf16 v[80:95], v[64:67], v[208:211], v[80:95]
    ds_read_b128 v[216:219], v4 offset:16384
    ds_read_b64_tr_b16 v[72:73], v8 offset:40960
    ds_read_b64_tr_b16 v[74:75], v8 offset:41472
    v_mfma_f32_16x16x32_bf16 v[112:115], v[36:39], v[64:67], v[112:115]
    s_add_u32 m0, s100, 122880
    s_add_u32 s65, s65, 128
    buffer_load_dwordx4 v22, s[20:23], s101 offen lds
    s_and_b32 s65, s65, 1023
    s_setprio 0
    s_waitcnt lgkmcnt(3)
    v_mfma_f32_32x32x16_bf16 v[80:95], v[68:71], v[212:215], v[80:95]
    ds_read_b128 v[220:223], v5 offset:16384
    ds_read_b64_tr_b16 v[76:77], v9 offset:40960
    ds_read_b64_tr_b16 v[78:79], v9 offset:41472
    s_waitcnt lgkmcnt(5)
    v_mfma_f32_4x4x4_16b_bf16 v[52:55], v[216:217], v[216:217], v[52:55]
    v_mfma_f32_4x4x4_16b_bf16 v[60:63], v[218:219], v[218:219], v[60:63]
    v_mfma_f32_16x16x32_bf16 v[48:51], v[36:39], v[216:219], v[48:51]
    s_waitcnt vmcnt(3)
    s_barrier
    s_setprio 3
    s_waitcnt lgkmcnt(3)
    v_mfma_f32_32x32x16_bf16 v[80:95], v[72:75], v[216:219], v[80:95]
    ds_read_b128 v[224:227], v2 offset:32768
    ds_read_b64_tr_b16 v[64:65], v6 offset:49152
    ds_read_b64_tr_b16 v[66:67], v6 offset:49664
    s_add_u32 m0, s46, 0
    s_add_u32 s101, s32, 128
    buffer_load_dwordx4 v16, s[20:23], s101 offen lds
    s_setprio 2
    s_waitcnt lgkmcnt(3)
    v_mfma_f32_32x32x16_bf16 v[80:95], v[76:79], v[220:223], v[80:95]
    ds_read_b128 v[228:231], v3 offset:32768
    ds_read_b64_tr_b16 v[68:69], v7 offset:49152
    ds_read_b64_tr_b16 v[70:71], v7 offset:49664
    s_waitcnt lgkmcnt(5)
    v_mfma_f32_4x4x4_16b_bf16 v[52:55], v[224:225], v[224:225], v[52:55]
    v_mfma_f32_4x4x4_16b_bf16 v[60:63], v[226:227], v[226:227], v[60:63]
    v_mfma_f32_16x16x32_bf16 v[48:51], v[36:39], v[224:227], v[48:51]
    s_add_u32 s101, s101, 27648
    buffer_load_dwordx4 v16, s[20:23], s101 offen offset:1024 lds
    s_setprio 1
    s_waitcnt lgkmcnt(3)
    v_mfma_f32_32x32x16_bf16 v[80:95], v[64:67], v[224:227], v[80:95]
    ds_read_b128 v[232:235], v4 offset:32768
    ds_read_b64_tr_b16 v[72:73], v8 offset:49152
    ds_read_b64_tr_b16 v[74:75], v8 offset:49664
    v_mfma_f32_16x16x32_bf16 v[112:115], v[36:39], v[64:67], v[112:115]
    s_setprio 0
    s_waitcnt lgkmcnt(3)
    v_mfma_f32_32x32x16_bf16 v[80:95], v[68:71], v[228:231], v[80:95]
    ds_read_b128 v[236:239], v5 offset:32768
    ds_read_b64_tr_b16 v[76:77], v9 offset:49152
    ds_read_b64_tr_b16 v[78:79], v9 offset:49664
    s_waitcnt lgkmcnt(5)
    v_mfma_f32_4x4x4_16b_bf16 v[52:55], v[232:233], v[232:233], v[52:55]
    v_mfma_f32_4x4x4_16b_bf16 v[60:63], v[234:235], v[234:235], v[60:63]
    v_mfma_f32_16x16x32_bf16 v[48:51], v[36:39], v[232:235], v[48:51]
    s_waitcnt vmcnt(2)
    s_barrier
    s_setprio 3
    s_waitcnt lgkmcnt(3)
    v_mfma_f32_32x32x16_bf16 v[80:95], v[72:75], v[232:235], v[80:95]
    ds_read_b128 v[240:243], v2 offset:49152
    ds_read_b64_tr_b16 v[64:65], v6 offset:57344
    ds_read_b64_tr_b16 v[66:67], v6 offset:57856
    s_add_u32 m0, s46, 16384
    s_add_u32 s101, s33, 128
    buffer_load_dwordx4 v16, s[20:23], s101 offen lds
    s_setprio 2
    s_waitcnt lgkmcnt(3)
    v_mfma_f32_32x32x16_bf16 v[80:95], v[76:79], v[236:239], v[80:95]
    ds_read_b128 v[244:247], v3 offset:49152
    ds_read_b64_tr_b16 v[68:69], v7 offset:57344
    ds_read_b64_tr_b16 v[70:71], v7 offset:57856
    s_waitcnt lgkmcnt(5)
    v_mfma_f32_4x4x4_16b_bf16 v[52:55], v[240:241], v[240:241], v[52:55]
    v_mfma_f32_4x4x4_16b_bf16 v[60:63], v[242:243], v[242:243], v[60:63]
    v_mfma_f32_16x16x32_bf16 v[48:51], v[36:39], v[240:243], v[48:51]
    s_add_u32 s101, s101, 27648
    buffer_load_dwordx4 v16, s[20:23], s101 offen offset:1024 lds
    s_setprio 1
    s_waitcnt lgkmcnt(3)
    v_mfma_f32_32x32x16_bf16 v[80:95], v[64:67], v[240:243], v[80:95]
    ds_read_b128 v[248:251], v4 offset:49152
    ds_read_b64_tr_b16 v[72:73], v8 offset:57344
    ds_read_b64_tr_b16 v[74:75], v8 offset:57856
    v_and_b32 v20, 3, v1
    v_cmp_eq_u32 s[60:61], 1, v20
    s_lshl_b32 s47, s52, 3
    v_add_u32 v44, s47, v19
    v_mfma_f32_16x16x32_bf16 v[112:115], v[36:39], v[64:67], v[112:115]
    s_setprio 0
    s_waitcnt lgkmcnt(3)
    v_mfma_f32_32x32x16_bf16 v[80:95], v[68:71], v[244:247], v[80:95]
    ds_read_b128 v[252:255], v5 offset:49152
    ds_read_b64_tr_b16 v[76:77], v9 offset:57344
    ds_read_b64_tr_b16 v[78:79], v9 offset:57856
    s_waitcnt lgkmcnt(5)
    v_mfma_f32_4x4x4_16b_bf16 v[52:55], v[248:249], v[248:249], v[52:55]
    v_mfma_f32_4x4x4_16b_bf16 v[60:63], v[250:251], v[250:251], v[60:63]
    v_mfma_f32_16x16x32_bf16 v[48:51], v[36:39], v[248:251], v[48:51]
    s_nop 3
    v_add_f32 v52, v52, v60
    v_add_f32 v53, v53, v61
    v_add_f32 v54, v54, v62
    v_add_f32 v55, v55, v63
    v_cmp_eq_u32 vcc, 2, v20
    v_cndmask_b32 v21, v52, v53, s[60:61]
    v_cmp_eq_u32 s[60:61], 3, v20
    v_cndmask_b32 v21, v21, v54, vcc
    s_nop 0
    v_cndmask_b32 v21, v21, v55, s[60:61]
    v_mov_b32 v20, v21
    s_nop 1
    v_permlane32_swap_b32 v20, v21
    v_add_f32 v49, v20, v21
    ds_write_b64 v44, v[48:49]
    v_add_u32 v113, s58, v0
    ds_write_b32 v113, v112 offset:0
    s_waitcnt vmcnt(2) lgkmcnt(0)
    s_barrier
    s_setprio 3
    v_mfma_f32_32x32x16_bf16 v[80:95], v[72:75], v[248:251], v[80:95]
    v_xor_b32 v6, 65536, v6
    ds_read_b64_tr_b16 v[64:65], v6 offset:0
    ds_read_b64_tr_b16 v[66:67], v6 offset:512
    ds_read_b128 v[48:51], v19
    ds_read_b128 v[116:119], v0
    s_add_u32 m0, s46, 32768
    s_add_u32 s101, s34, 128
    buffer_load_dwordx4 v16, s[20:23], s101 offen lds
    s_setprio 2
    v_mfma_f32_32x32x16_bf16 v[80:95], v[76:79], v[252:255], v[80:95]
    v_xor_b32 v7, 65536, v7
    ds_read_b64_tr_b16 v[68:69], v7 offset:0
    ds_read_b64_tr_b16 v[70:71], v7 offset:512
    s_add_u32 s101, s101, 27648
    buffer_load_dwordx4 v16, s[20:23], s101 offen offset:1024 lds
    s_setprio 3
    s_waitcnt lgkmcnt(4)
    v_mfma_f32_32x32x16_bf16 v[96:111], v[64:67], v[128:131], 0
    v_xor_b32 v8, 65536, v8
    ds_read_b64_tr_b16 v[72:73], v8 offset:0
    ds_read_b64_tr_b16 v[74:75], v8 offset:512
    v_mfma_f32_16x16x32_bf16 v[112:115], v[36:39], v[64:67], 0
    s_waitcnt lgkmcnt(5)
    v_add_f32 v20, v48, v50
    v_add_f32 v21, v49, v51
    v_mul_f32 v20, 0xbb000000, v20
    v_mul_f32 v60, v20, v20
    s_add_u32 m0, s46, 49152
    s_add_u32 s101, s35, 128
    buffer_load_dwordx4 v16, s[20:23], s101 offen lds
    s_waitcnt lgkmcnt(2)
    v_mfma_f32_32x32x16_bf16 v[96:111], v[68:71], v[132:135], v[96:111]
    v_xor_b32 v9, 65536, v9
    ds_read_b64_tr_b16 v[76:77], v9 offset:0
    ds_read_b64_tr_b16 v[78:79], v9 offset:512
    v_fma_f32 v21, v21, s59, -v60
    v_max_f32 v21, 0, v21
    v_cvt_pk_bf16_f32 v60, v21, v20
    v_lshlrev_b32 v21, 16, v60
    v_add_f32 v21, 0x3727c5ac, v21
    s_add_u32 s101, s101, 27648
    buffer_load_dwordx4 v16, s[20:23], s101 offen offset:1024 lds
    s_setprio 2
    s_waitcnt lgkmcnt(2)
    v_mfma_f32_32x32x16_bf16 v[96:111], v[72:75], v[136:139], v[96:111]
    ds_read_b64_tr_b16 v[64:65], v6 offset:8192
    ds_read_b64_tr_b16 v[66:67], v6 offset:8704
    v_cvt_pk_bf16_f32 v21, v21, v21
    v_and_b32 v21, 0xffff0000, v21
    v_sqrt_f32 v21, v21
    v_lshrrev_b32 v28, 16, v60
    v_cmp_gt_u32 vcc, 32, v1
    s_waitcnt lgkmcnt(2)
    v_mfma_f32_32x32x16_bf16 v[96:111], v[76:79], v[140:143], v[96:111]
    ds_read_b64_tr_b16 v[68:69], v7 offset:8192
    ds_read_b64_tr_b16 v[70:71], v7 offset:8704
    v_cvt_pk_bf16_f32 v29, v20, v21
    v_mov_b32 v30, 0
    v_and_b32 v24, 0xffff0000, v29
    v_rcp_f32 v23, v24
    v_cndmask_b32 v28, 0, v28, vcc
    s_add_u32 m0, s46, 65536
    s_add_u32 s101, s32, 256
    buffer_load_dwordx4 v16, s[20:23], s101 offen lds
    s_setprio 1
    s_waitcnt lgkmcnt(2)
    v_mfma_f32_32x32x16_bf16 v[96:111], v[64:67], v[144:147], v[96:111]
    ds_read_b64_tr_b16 v[72:73], v8 offset:8192
    ds_read_b64_tr_b16 v[74:75], v8 offset:8704
    v_mfma_f32_16x16x32_bf16 v[112:115], v[36:39], v[64:67], v[112:115]
    v_cndmask_b32 v29, 0, v29, vcc
    v_add_f32 v22, v116, v117
    v_add_f32 v118, v118, v119
    v_add_f32 v22, v22, v118
    v_cvt_pk_bf16_f32 v32, v22, v22
    s_waitcnt lgkmcnt(2)
    v_mfma_f32_32x32x16_bf16 v[96:111], v[68:71], v[148:151], v[96:111]
    ds_read_b64_tr_b16 v[76:77], v9 offset:8192
    ds_read_b64_tr_b16 v[78:79], v9 offset:8704
    v_and_b32 v62, 0xffff0000, v32
    v_sub_f32 v62, v22, v62
    v_cvt_pk_bf16_f32 v62, v62, 0
    v_mov_b32 v34, v40
    v_lshl_or_b32 v33, v40, 16, v62
    s_add_u32 s101, s101, 27648
    buffer_load_dwordx4 v16, s[20:23], s101 offen offset:1024 lds
    s_setprio 0
    s_waitcnt lgkmcnt(2)
    v_mfma_f32_32x32x16_bf16 v[96:111], v[72:75], v[152:155], v[96:111]
    s_waitcnt vmcnt(2)
    s_barrier
    ds_read_b64_tr_b16 v[64:65], v6 offset:16384
    ds_read_b64_tr_b16 v[66:67], v6 offset:16896
    v_mfma_f32_32x32x16_bf16 v[80:95], v[32:35], v[28:31], v[80:95]
    v_mul_f32 v25, 0xc0135761, v23
    v_mul_f32 v26, v23, v23
    v_mul_f32 v26, v26, v23
    v_mul_f32 v26, 0xbdd2d3e8, v26
    s_add_u32 m0, s46, 81920
    s_add_u32 s101, s33, 256
    buffer_load_dwordx4 v16, s[20:23], s101 offen lds
    s_cmp_eq_u32 s3, 7
    s_cbranch_scc0 L_npf
    v_and_b32 v14, 28, v1
    buffer_load_dword v14, v14, s[28:31], 0 offen sc1
L_npf:
    s_waitcnt lgkmcnt(2)
    v_mfma_f32_32x32x16_bf16 v[96:111], v[76:79], v[156:159], v[96:111]
    ds_read_b64_tr_b16 v[68:69], v7 offset:16384
    ds_read_b64_tr_b16 v[70:71], v7 offset:16896
    v_mul_f32 v52, v80, v80
    v_mul_f32 v53, v81, v81
    v_mul_f32 v54, v82, v82
    v_mul_f32 v55, v83, v83
    s_setprio 3
    s_waitcnt lgkmcnt(2)
    v_mfma_f32_32x32x16_bf16 v[96:111], v[64:67], v[160:163], v[96:111]
    ds_read_b64_tr_b16 v[72:73], v8 offset:16384
    ds_read_b64_tr_b16 v[74:75], v8 offset:16896
    v_mfma_f32_16x16x32_bf16 v[112:115], v[36:39], v[64:67], v[112:115]
    v_fma_f32 v52, v52, v26, v25
    v_fma_f32 v53, v53, v26, v25
    v_fma_f32 v54, v54, v26, v25
    v_fma_f32 v55, v55, v26, v25
    v_mul_f32 v52, v80, v52
    s_add_u32 s101, s101, 27648
    buffer_load_dwordx4 v16, s[20:23], s101 offen offset:1024 lds
    s_waitcnt lgkmcnt(2)
    v_mfma_f32_32x32x16_bf16 v[96:111], v[68:71], v[164:167], v[96:111]
    ds_read_b64_tr_b16 v[76:77], v9 offset:16384
    ds_read_b64_tr_b16 v[78:79], v9 offset:16896
    v_mul_f32 v53, v81, v53
    v_mul_f32 v54, v82, v54
    v_mul_f32 v55, v83, v55
    v_exp_f32 v52, v52
    v_exp_f32 v53, v53
    s_add_u32 m0, s46, 98304
    s_add_u32 s101, s34, 256
    buffer_load_dwordx4 v16, s[20:23], s101 offen lds
    s_setprio 2
    s_waitcnt lgkmcnt(2)
    v_mfma_f32_32x32x16_bf16 v[96:111], v[72:75], v[168:171], v[96:111]
    ds_read_b64_tr_b16 v[64:65], v6 offset:24576
    ds_read_b64_tr_b16 v[66:67], v6 offset:25088
    v_exp_f32 v54, v54
    v_exp_f32 v55, v55
    v_fma_f32 v52, v52, v24, v24
    v_fma_f32 v53, v53, v24, v24
    v_fma_f32 v54, v54, v24, v24
    s_waitcnt lgkmcnt(2)
    v_mfma_f32_32x32x16_bf16 v[96:111], v[76:79], v[172:175], v[96:111]
    ds_read_b64_tr_b16 v[68:69], v7 offset:24576
    ds_read_b64_tr_b16 v[70:71], v7 offset:25088
    v_fma_f32 v55, v55, v24, v24
    v_rcp_f32 v52, v52
    v_rcp_f32 v53, v53
    v_rcp_f32 v54, v54
    v_rcp_f32 v55, v55
    s_add_u32 s101, s101, 27648
    buffer_load_dwordx4 v16, s[20:23], s101 offen offset:1024 lds
    s_setprio 1
    s_waitcnt lgkmcnt(2)
    v_mfma_f32_32x32x16_bf16 v[96:111], v[64:67], v[176:179], v[96:111]
    ds_read_b64_tr_b16 v[72:73], v8 offset:24576
    ds_read_b64_tr_b16 v[74:75], v8 offset:25088
    v_mfma_f32_16x16x32_bf16 v[112:115], v[36:39], v[64:67], v[112:115]
    v_mul_f32 v52, v80, v52
    v_mul_f32 v53, v81, v53
    v_mul_f32 v54, v82, v54
    v_mul_f32 v55, v83, v55
    v_cvt_pk_bf16_f32 v44, v52, v53
    s_add_u32 m0, s46, 114688
    s_add_u32 s101, s35, 256
    buffer_load_dwordx4 v16, s[20:23], s101 offen lds
    s_waitcnt lgkmcnt(2)
    v_mfma_f32_32x32x16_bf16 v[96:111], v[68:71], v[180:183], v[96:111]
    ds_read_b64_tr_b16 v[76:77], v9 offset:24576
    ds_read_b64_tr_b16 v[78:79], v9 offset:25088
    v_cvt_pk_bf16_f32 v45, v54, v55
    v_mul_f32 v56, v84, v84
    v_mul_f32 v57, v85, v85
    v_mul_f32 v58, v86, v86
    v_mul_f32 v59, v87, v87
    s_setprio 0
    s_waitcnt lgkmcnt(2)
    v_mfma_f32_32x32x16_bf16 v[96:111], v[72:75], v[184:187], v[96:111]
    ds_read_b64_tr_b16 v[64:65], v6 offset:32768
    ds_read_b64_tr_b16 v[66:67], v6 offset:33280
    v_fma_f32 v56, v56, v26, v25
    v_fma_f32 v57, v57, v26, v25
    v_fma_f32 v58, v58, v26, v25
    v_fma_f32 v59, v59, v26, v25
    v_mul_f32 v56, v84, v56
    s_add_u32 s101, s101, 27648
    buffer_load_dwordx4 v16, s[20:23], s101 offen offset:1024 lds
    s_waitcnt lgkmcnt(2)
    v_mfma_f32_32x32x16_bf16 v[96:111], v[76:79], v[188:191], v[96:111]
    ds_read_b64_tr_b16 v[68:69], v7 offset:32768
    ds_read_b64_tr_b16 v[70:71], v7 offset:33280
    v_mul_f32 v57, v85, v57
    v_mul_f32 v58, v86, v58
    v_mul_f32 v59, v87, v59
    v_exp_f32 v56, v56
    v_exp_f32 v57, v57
    s_setprio 3
    s_waitcnt lgkmcnt(2)
    v_mfma_f32_32x32x16_bf16 v[96:111], v[64:67], v[192:195], v[96:111]
    ds_read_b64_tr_b16 v[72:73], v8 offset:32768
    ds_read_b64_tr_b16 v[74:75], v8 offset:33280
    v_mfma_f32_16x16x32_bf16 v[112:115], v[36:39], v[64:67], v[112:115]
    v_exp_f32 v58, v58
    v_exp_f32 v59, v59
    v_fma_f32 v56, v56, v24, v24
    v_fma_f32 v57, v57, v24, v24
    v_fma_f32 v58, v58, v24, v24
    s_waitcnt lgkmcnt(2)
    v_mfma_f32_32x32x16_bf16 v[96:111], v[68:71], v[196:199], v[96:111]
    ds_read_b64_tr_b16 v[76:77], v9 offset:32768
    ds_read_b64_tr_b16 v[78:79], v9 offset:33280
    v_fma_f32 v59, v59, v24, v24
    v_rcp_f32 v56, v56
    v_rcp_f32 v57, v57
    v_rcp_f32 v58, v58
    v_rcp_f32 v59, v59
    s_setprio 2
    s_waitcnt lgkmcnt(2)
    v_mfma_f32_32x32x16_bf16 v[96:111], v[72:75], v[200:203], v[96:111]
    ds_read_b64_tr_b16 v[64:65], v6 offset:40960
    ds_read_b64_tr_b16 v[66:67], v6 offset:41472
    v_mul_f32 v56, v84, v56
    v_mul_f32 v57, v85, v57
    v_mul_f32 v58, v86, v58
    v_mul_f32 v59, v87, v59
    v_cvt_pk_bf16_f32 v46, v56, v57
    s_waitcnt lgkmcnt(2)
    v_mfma_f32_32x32x16_bf16 v[96:111], v[76:79], v[204:207], v[96:111]
    ds_read_b64_tr_b16 v[68:69], v7 offset:40960
    ds_read_b64_tr_b16 v[70:71], v7 offset:41472
    v_cvt_pk_bf16_f32 v47, v58, v59
    v_mul_f32 v52, v88, v88
    v_mul_f32 v53, v89, v89
    v_mul_f32 v54, v90, v90
    s_setprio 1
    s_waitcnt lgkmcnt(2)
    v_mfma_f32_32x32x16_bf16 v[96:111], v[64:67], v[208:211], v[96:111]
    ds_read_b64_tr_b16 v[72:73], v8 offset:40960
    ds_read_b64_tr_b16 v[74:75], v8 offset:41472
    v_mfma_f32_16x16x32_bf16 v[112:115], v[36:39], v[64:67], v[112:115]
    v_mul_f32 v55, v91, v91
    v_fma_f32 v52, v52, v26, v25
    v_fma_f32 v53, v53, v26, v25
    v_fma_f32 v54, v54, v26, v25
    v_fma_f32 v55, v55, v26, v25
    s_waitcnt lgkmcnt(2)
    v_mfma_f32_32x32x16_bf16 v[96:111], v[68:71], v[212:215], v[96:111]
    ds_read_b64_tr_b16 v[76:77], v9 offset:40960
    ds_read_b64_tr_b16 v[78:79], v9 offset:41472
    v_mul_f32 v52, v88, v52
    v_mul_f32 v53, v89, v53
    v_mul_f32 v54, v90, v54
    v_mul_f32 v55, v91, v55
    v_exp_f32 v52, v52
    s_setprio 0
    s_waitcnt lgkmcnt(2)
    v_mfma_f32_32x32x16_bf16 v[96:111], v[72:75], v[216:219], v[96:111]
    ds_read_b64_tr_b16 v[64:65], v6 offset:49152
    ds_read_b64_tr_b16 v[66:67], v6 offset:49664
    v_exp_f32 v53, v53
    v_exp_f32 v54, v54
    v_exp_f32 v55, v55
    v_fma_f32 v52, v52, v24, v24
    v_fma_f32 v53, v53, v24, v24
    s_waitcnt lgkmcnt(2)
    v_mfma_f32_32x32x16_bf16 v[96:111], v[76:79], v[220:223], v[96:111]
    ds_read_b64_tr_b16 v[68:69], v7 offset:49152
    ds_read_b64_tr_b16 v[70:71], v7 offset:49664
    v_fma_f32 v54, v54, v24, v24
    v_fma_f32 v55, v55, v24, v24
    v_rcp_f32 v52, v52
    v_rcp_f32 v53, v53
    v_rcp_f32 v54, v54
    s_setprio 3
    s_waitcnt lgkmcnt(2)
    v_mfma_f32_32x32x16_bf16 v[96:111], v[64:67], v[224:227], v[96:111]
    ds_read_b64_tr_b16 v[72:73], v8 offset:49152
    ds_read_b64_tr_b16 v[74:75], v8 offset:49664
    v_mfma_f32_16x16x32_bf16 v[112:115], v[36:39], v[64:67], v[112:115]
    v_rcp_f32 v55, v55
    v_mul_f32 v52, v88, v52
    v_mul_f32 v53, v89, v53
    v_mul_f32 v54, v90, v54
    v_mul_f32 v55, v91, v55
    s_waitcnt lgkmcnt(2)
    v_mfma_f32_32x32x16_bf16 v[96:111], v[68:71], v[228:231], v[96:111]
    ds_read_b64_tr_b16 v[76:77], v9 offset:49152
    ds_read_b64_tr_b16 v[78:79], v9 offset:49664
    v_cvt_pk_bf16_f32 v48, v52, v53
    v_cvt_pk_bf16_f32 v49, v54, v55
    v_mul_f32 v56, v92, v92
    v_mul_f32 v57, v93, v93
    v_mul_f32 v58, v94, v94
    s_setprio 2
    s_waitcnt lgkmcnt(2)
    v_mfma_f32_32x32x16_bf16 v[96:111], v[72:75], v[232:235], v[96:111]
    ds_read_b64_tr_b16 v[64:65], v6 offset:57344
    ds_read_b64_tr_b16 v[66:67], v6 offset:57856
    v_mul_f32 v59, v95, v95
    v_fma_f32 v56, v56, v26, v25
    v_fma_f32 v57, v57, v26, v25
    v_fma_f32 v58, v58, v26, v25
    v_fma_f32 v59, v59, v26, v25
    s_waitcnt lgkmcnt(2)
    v_mfma_f32_32x32x16_bf16 v[96:111], v[76:79], v[236:239], v[96:111]
    ds_read_b64_tr_b16 v[68:69], v7 offset:57344
    ds_read_b64_tr_b16 v[70:71], v7 offset:57856
    v_mul_f32 v56, v92, v56
    v_mul_f32 v57, v93, v57
    v_mul_f32 v58, v94, v58
    v_mul_f32 v59, v95, v59
    v_exp_f32 v56, v56
    s_setprio 1
    s_waitcnt lgkmcnt(2)
    v_mfma_f32_32x32x16_bf16 v[96:111], v[64:67], v[240:243], v[96:111]
    ds_read_b64_tr_b16 v[72:73], v8 offset:57344
    ds_read_b64_tr_b16 v[74:75], v8 offset:57856
    v_mfma_f32_16x16x32_bf16 v[112:115], v[36:39], v[64:67], v[112:115]
    v_exp_f32 v57, v57
    v_exp_f32 v58, v58
    v_exp_f32 v59, v59
    v_fma_f32 v56, v56, v24, v24
    v_fma_f32 v57, v57, v24, v24
    s_waitcnt lgkmcnt(2)
    v_mfma_f32_32x32x16_bf16 v[96:111], v[68:71], v[244:247], v[96:111]
    ds_read_b64_tr_b16 v[76:77], v9 offset:57344
    ds_read_b64_tr_b16 v[78:79], v9 offset:57856
    v_add_u32 v113, s58, v0
    ds_write_b32 v113, v112 offset:1024
    v_fma_f32 v58, v58, v24, v24
    v_fma_f32 v59, v59, v24, v24
    v_rcp_f32 v56, v56
    v_rcp_f32 v57, v57
    v_rcp_f32 v58, v58
    s_cmp_eq_u32 s3, 7
    s_cbranch_scc0 L_ncf
    s_waitcnt vmcnt(5)
    v_mov_b32 v14, v14
    s_mov_b32 s57, 0
L_ncsf:
    v_cmp_ne_u32 vcc, 1, v14
    s_add_u32 s57, s57, 1
    s_cbranch_vccz L_ncsf_ok
    s_cmp_gt_u32 s57, 32768
    s_cbranch_scc1 L_ncsf_ok
    s_sleep 1
    v_and_b32 v14, 28, v1
    buffer_load_dword v14, v14, s[28:31], 0 offen sc1
    s_waitcnt vmcnt(0)
    s_branch L_ncsf
L_ncsf_ok:
L_ncf:
    s_setprio 0
    s_waitcnt lgkmcnt(3)
    v_mfma_f32_32x32x16_bf16 v[96:111], v[72:75], v[248:251], v[96:111]
    s_waitcnt vmcnt(0) lgkmcnt(0)
    s_barrier
    v_xor_b32 v6, 65536, v6
    ds_read_b64_tr_b16 v[64:65], v6 offset:0
    ds_read_b64_tr_b16 v[66:67], v6 offset:512
    ds_read_b128 v[116:119], v0 offset:1024
    v_rcp_f32 v59, v59
    v_mul_f32 v56, v92, v56
    v_mul_f32 v57, v93, v57
    v_mul_f32 v58, v94, v58
    v_mul_f32 v59, v95, v59
    v_mfma_f32_32x32x16_bf16 v[96:111], v[76:79], v[252:255], v[96:111]
    v_xor_b32 v7, 65536, v7
    ds_read_b64_tr_b16 v[68:69], v7 offset:0
    ds_read_b64_tr_b16 v[70:71], v7 offset:512
    v_cvt_pk_bf16_f32 v50, v56, v57
    v_cvt_pk_bf16_f32 v51, v58, v59
    buffer_store_dwordx4 v[44:47], v27, s[16:19], s62 offen offset:0 sc1
    buffer_store_dwordx4 v[48:51], v27, s[16:19], s62 offen offset:1024 sc1
    s_add_u32 s62, s62, 4096
    s_setprio 3
    s_waitcnt lgkmcnt(3)
    v_mfma_f32_32x32x16_bf16 v[80:95], v[64:67], v[128:131], 0
    v_xor_b32 v8, 65536, v8
    ds_read_b64_tr_b16 v[72:73], v8 offset:0
    ds_read_b64_tr_b16 v[74:75], v8 offset:512
    v_mfma_f32_16x16x32_bf16 v[112:115], v[36:39], v[64:67], 0
    s_waitcnt lgkmcnt(4)
    v_add_f32 v22, v116, v117
    v_add_f32 v118, v118, v119
    v_add_f32 v22, v22, v118
    v_cvt_pk_bf16_f32 v32, v22, v22
    v_and_b32 v62, 0xffff0000, v32
    s_lshr_b32 s101, s46, 1
    s_add_u32 m0, s101, 0
    s_nop 0
    buffer_load_dwordx4 v18, s[20:23], s32 offen lds
    s_waitcnt lgkmcnt(2)
    v_mfma_f32_32x32x16_bf16 v[80:95], v[68:71], v[132:135], v[80:95]
    v_xor_b32 v9, 65536, v9
    ds_read_b64_tr_b16 v[76:77], v9 offset:0
    ds_read_b64_tr_b16 v[78:79], v9 offset:512
    v_sub_f32 v62, v22, v62
    v_cvt_pk_bf16_f32 v62, v62, 0
    v_mov_b32 v34, v41
    v_lshl_or_b32 v33, v41, 16, v62
    s_nop 1
    v_mfma_f32_32x32x16_bf16 v[96:111], v[32:35], v[28:31], v[96:111]
    s_setprio 2
    s_waitcnt lgkmcnt(2)
    v_mfma_f32_32x32x16_bf16 v[80:95], v[72:75], v[136:139], v[80:95]
    ds_read_b64_tr_b16 v[64:65], v6 offset:8192
    ds_read_b64_tr_b16 v[66:67], v6 offset:8704
    s_waitcnt lgkmcnt(2)
    v_mfma_f32_32x32x16_bf16 v[80:95], v[76:79], v[140:143], v[80:95]
    ds_read_b64_tr_b16 v[68:69], v7 offset:8192
    ds_read_b64_tr_b16 v[70:71], v7 offset:8704
    s_nop 2
    v_mul_f32 v52, v96, v96
    v_mul_f32 v53, v97, v97
    v_mul_f32 v54, v98, v98
    v_mul_f32 v55, v99, v99
    s_setprio 1
    s_waitcnt lgkmcnt(2)
    v_mfma_f32_32x32x16_bf16 v[80:95], v[64:67], v[144:147], v[80:95]
    ds_read_b64_tr_b16 v[72:73], v8 offset:8192
    ds_read_b64_tr_b16 v[74:75], v8 offset:8704
    v_mfma_f32_16x16x32_bf16 v[112:115], v[36:39], v[64:67], v[112:115]
    v_fma_f32 v52, v52, v26, v25
    v_fma_f32 v53, v53, v26, v25
    v_fma_f32 v54, v54, v26, v25
    v_fma_f32 v55, v55, v26, v25
    s_lshr_b32 s101, s46, 1
    s_add_u32 m0, s101, 8192
    s_nop 0
    buffer_load_dwordx4 v18, s[20:23], s33 offen lds
    s_waitcnt lgkmcnt(2)
    v_mfma_f32_32x32x16_bf16 v[80:95], v[68:71], v[148:151], v[80:95]
    ds_read_b64_tr_b16 v[76:77], v9 offset:8192
    ds_read_b64_tr_b16 v[78:79], v9 offset:8704
    v_mul_f32 v52, v96, v52
    v_mul_f32 v53, v97, v53
    v_mul_f32 v54, v98, v54
    v_mul_f32 v55, v99, v55
    s_setprio 0
    s_waitcnt lgkmcnt(2)
    v_mfma_f32_32x32x16_bf16 v[80:95], v[72:75], v[152:155], v[80:95]
    ds_read_b64_tr_b16 v[64:65], v6 offset:16384
    ds_read_b64_tr_b16 v[66:67], v6 offset:16896
    v_exp_f32 v52, v52
    v_exp_f32 v53, v53
    v_exp_f32 v54, v54
    v_exp_f32 v55, v55
    s_waitcnt lgkmcnt(2)
    v_mfma_f32_32x32x16_bf16 v[80:95], v[76:79], v[156:159], v[80:95]
    ds_read_b64_tr_b16 v[68:69], v7 offset:16384
    ds_read_b64_tr_b16 v[70:71], v7 offset:16896
    v_fma_f32 v52, v52, v24, v24
    v_fma_f32 v53, v53, v24, v24
    v_fma_f32 v54, v54, v24, v24
    v_fma_f32 v55, v55, v24, v24
    v_rcp_f32 v52, v52
    s_setprio 3
    s_waitcnt lgkmcnt(2)
    v_mfma_f32_32x32x16_bf16 v[80:95], v[64:67], v[160:163], v[80:95]
    ds_read_b64_tr_b16 v[72:73], v8 offset:16384
    ds_read_b64_tr_b16 v[74:75], v8 offset:16896
    v_mfma_f32_16x16x32_bf16 v[112:115], v[36:39], v[64:67], v[112:115]
    v_rcp_f32 v53, v53
    v_rcp_f32 v54, v54
    v_rcp_f32 v55, v55
    v_mul_f32 v52, v96, v52
    s_lshr_b32 s101, s46, 1
    s_add_u32 m0, s101, 16384
    s_nop 0
    buffer_load_dwordx4 v18, s[20:23], s34 offen lds
    s_waitcnt lgkmcnt(2)
    v_mfma_f32_32x32x16_bf16 v[80:95], v[68:71], v[164:167], v[80:95]
    ds_read_b64_tr_b16 v[76:77], v9 offset:16384
    ds_read_b64_tr_b16 v[78:79], v9 offset:16896
    v_mul_f32 v53, v97, v53
    v_mul_f32 v54, v98, v54
    v_mul_f32 v55, v99, v55
    v_cvt_pk_bf16_f32 v44, v52, v53
    s_setprio 2
    s_waitcnt lgkmcnt(2)
    v_mfma_f32_32x32x16_bf16 v[80:95], v[72:75], v[168:171], v[80:95]
    ds_read_b64_tr_b16 v[64:65], v6 offset:24576
    ds_read_b64_tr_b16 v[66:67], v6 offset:25088
    v_cvt_pk_bf16_f32 v45, v54, v55
    v_mul_f32 v56, v100, v100
    v_mul_f32 v57, v101, v101
    v_mul_f32 v58, v102, v102
    s_add_u32 s100, s98, 0
    s_and_b32 s100, s100, 3
    s_add_u32 s100, s100, s64
    s_lshl_b32 s100, s100, 14
    s_add_u32 m0, s49, 131072
    s_add_u32 s100, s100, s90
    buffer_load_dwordx4 v17, s[12:15], s100 offen lds
    s_waitcnt lgkmcnt(2)
    v_mfma_f32_32x32x16_bf16 v[80:95], v[76:79], v[172:175], v[80:95]
    ds_read_b64_tr_b16 v[68:69], v7 offset:24576
    ds_read_b64_tr_b16 v[70:71], v7 offset:25088
    v_mul_f32 v59, v103, v103
    v_fma_f32 v56, v56, v26, v25
    v_fma_f32 v57, v57, v26, v25
    v_fma_f32 v58, v58, v26, v25
    v_fma_f32 v59, v59, v26, v25
    s_add_u32 s100, s98, 1
    s_and_b32 s100, s100, 3
    s_add_u32 s100, s100, s64
    s_lshl_b32 s100, s100, 14
    s_add_u32 m0, s49, 135168
    s_add_u32 s100, s100, s90
    buffer_load_dwordx4 v17, s[12:15], s100 offen lds
    s_setprio 1
    s_waitcnt lgkmcnt(2)
    v_mfma_f32_32x32x16_bf16 v[80:95], v[64:67], v[176:179], v[80:95]
    ds_read_b64_tr_b16 v[72:73], v8 offset:24576
    ds_read_b64_tr_b16 v[74:75], v8 offset:25088
    v_mfma_f32_16x16x32_bf16 v[112:115], v[36:39], v[64:67], v[112:115]
    v_mul_f32 v56, v100, v56
    v_mul_f32 v57, v101, v57
    v_mul_f32 v58, v102, v58
    v_mul_f32 v59, v103, v59
    s_lshr_b32 s101, s46, 1
    s_add_u32 m0, s101, 24576
    s_nop 0
    buffer_load_dwordx4 v18, s[20:23], s35 offen lds
    s_waitcnt lgkmcnt(2)
    v_mfma_f32_32x32x16_bf16 v[80:95], v[68:71], v[180:183], v[80:95]
    ds_read_b64_tr_b16 v[76:77], v9 offset:24576
    ds_read_b64_tr_b16 v[78:79], v9 offset:25088
    v_exp_f32 v56, v56
    v_exp_f32 v57, v57
    v_exp_f32 v58, v58
    v_exp_f32 v59, v59
    s_setprio 0
    s_waitcnt lgkmcnt(2)
    v_mfma_f32_32x32x16_bf16 v[80:95], v[72:75], v[184:187], v[80:95]
    ds_read_b64_tr_b16 v[64:65], v6 offset:32768
    ds_read_b64_tr_b16 v[66:67], v6 offset:33280
    v_fma_f32 v56, v56, v24, v24
    v_fma_f32 v57, v57, v24, v24
    v_fma_f32 v58, v58, v24, v24
    v_fma_f32 v59, v59, v24, v24
    s_add_u32 s100, s98, 2
    s_and_b32 s100, s100, 3
    s_add_u32 s100, s100, s64
    s_lshl_b32 s100, s100, 14
    s_add_u32 m0, s49, 32768
    s_add_u32 s100, s100, s90
    buffer_load_dwordx4 v17, s[12:15], s100 offen lds
    s_waitcnt lgkmcnt(2)
    v_mfma_f32_32x32x16_bf16 v[80:95], v[76:79], v[188:191], v[80:95]
    ds_read_b64_tr_b16 v[68:69], v7 offset:32768
    ds_read_b64_tr_b16 v[70:71], v7 offset:33280
    v_rcp_f32 v56, v56
    v_rcp_f32 v57, v57
    v_rcp_f32 v58, v58
    v_rcp_f32 v59, v59
    v_mul_f32 v56, v100, v56
    s_setprio 3
    s_waitcnt lgkmcnt(2)
    v_mfma_f32_32x32x16_bf16 v[80:95], v[64:67], v[192:195], v[80:95]
    ds_read_b64_tr_b16 v[72:73], v8 offset:32768
    ds_read_b64_tr_b16 v[74:75], v8 offset:33280
    v_mfma_f32_16x16x32_bf16 v[112:115], v[36:39], v[64:67], v[112:115]
    v_mul_f32 v57, v101, v57
    v_mul_f32 v58, v102, v58
    v_mul_f32 v59, v103, v59
    v_cvt_pk_bf16_f32 v46, v56, v57
    s_add_u32 s100, s98, 3
    s_and_b32 s100, s100, 3
    s_add_u32 s100, s100, s64
    s_lshl_b32 s100, s100, 14
    s_add_u32 m0, s49, 36864
    s_add_u32 s100, s100, s90
    buffer_load_dwordx4 v17, s[12:15], s100 offen lds
    s_waitcnt lgkmcnt(2)
    v_mfma_f32_32x32x16_bf16 v[80:95], v[68:71], v[196:199], v[80:95]
    ds_read_b64_tr_b16 v[76:77], v9 offset:32768
    ds_read_b64_tr_b16 v[78:79], v9 offset:33280
    v_cvt_pk_bf16_f32 v47, v58, v59
    v_mul_f32 v52, v104, v104
    v_mul_f32 v53, v105, v105
    v_mul_f32 v54, v106, v106
    s_setprio 2
    s_waitcnt lgkmcnt(2)
    v_mfma_f32_32x32x16_bf16 v[80:95], v[72:75], v[200:203], v[80:95]
    s_barrier
    ds_read_b64_tr_b16 v[64:65], v6 offset:40960
    ds_read_b64_tr_b16 v[66:67], v6 offset:41472
    v_mul_f32 v55, v107, v107
    v_fma_f32 v52, v52, v26, v25
    v_fma_f32 v53, v53, v26, v25
    v_fma_f32 v54, v54, v26, v25
    s_add_u32 s100, s98, 4
    s_and_b32 s100, s100, 3
    s_add_u32 s100, s100, s64
    s_add_u32 s100, s100, 4
    s_lshl_b32 s100, s100, 14
    s_add_u32 m0, s49, 49152
    s_add_u32 s100, s100, s90
    buffer_load_dwordx4 v17, s[12:15], s100 offen lds
    s_waitcnt lgkmcnt(2)
    v_mfma_f32_32x32x16_bf16 v[80:95], v[76:79], v[204:207], v[80:95]
    ds_read_b64_tr_b16 v[68:69], v7 offset:40960
    ds_read_b64_tr_b16 v[70:71], v7 offset:41472
    v_fma_f32 v55, v55, v26, v25
    v_mul_f32 v52, v104, v52
    v_mul_f32 v53, v105, v53
    v_mul_f32 v54, v106, v54
    v_mul_f32 v55, v107, v55
    s_setprio 1
    s_waitcnt lgkmcnt(2)
    v_mfma_f32_32x32x16_bf16 v[80:95], v[64:67], v[208:211], v[80:95]
    ds_read_b64_tr_b16 v[72:73], v8 offset:40960
    ds_read_b64_tr_b16 v[74:75], v8 offset:41472
    v_mfma_f32_16x16x32_bf16 v[112:115], v[36:39], v[64:67], v[112:115]
    v_exp_f32 v52, v52
    v_exp_f32 v53, v53
    v_exp_f32 v54, v54
    v_exp_f32 v55, v55
    s_add_u32 s100, s98, 5
    s_and_b32 s100, s100, 3
    s_add_u32 s100, s100, s64
    s_add_u32 s100, s100, 4
    s_lshl_b32 s100, s100, 14
    s_add_u32 m0, s49, 53248
    s_add_u32 s100, s100, s90
    buffer_load_dwordx4 v17, s[12:15], s100 offen lds
    s_waitcnt lgkmcnt(2)
    v_mfma_f32_32x32x16_bf16 v[80:95], v[68:71], v[212:215], v[80:95]
    ds_read_b64_tr_b16 v[76:77], v9 offset:40960
    ds_read_b64_tr_b16 v[78:79], v9 offset:41472
    v_fma_f32 v52, v52, v24, v24
    v_fma_f32 v53, v53, v24, v24
    v_fma_f32 v54, v54, v24, v24
    v_fma_f32 v55, v55, v24, v24
    s_setprio 0
    s_waitcnt lgkmcnt(2)
    v_mfma_f32_32x32x16_bf16 v[80:95], v[72:75], v[216:219], v[80:95]
    ds_read_b64_tr_b16 v[64:65], v6 offset:49152
    ds_read_b64_tr_b16 v[66:67], v6 offset:49664
    v_rcp_f32 v52, v52
    v_rcp_f32 v53, v53
    v_rcp_f32 v54, v54
    v_rcp_f32 v55, v55
    s_add_u32 s100, s98, 6
    s_and_b32 s100, s100, 3
    s_add_u32 s100, s100, s64
    s_add_u32 s100, s100, 4
    s_lshl_b32 s100, s100, 14
    s_add_u32 m0, s49, 65536
    s_add_u32 s100, s100, s90
    buffer_load_dwordx4 v17, s[12:15], s100 offen lds
    s_waitcnt lgkmcnt(2)
    v_mfma_f32_32x32x16_bf16 v[80:95], v[76:79], v[220:223], v[80:95]
    ds_read_b64_tr_b16 v[68:69], v7 offset:49152
    ds_read_b64_tr_b16 v[70:71], v7 offset:49664
    v_mul_f32 v52, v104, v52
    v_mul_f32 v53, v105, v53
    v_mul_f32 v54, v106, v54
    v_mul_f32 v55, v107, v55
    v_cvt_pk_bf16_f32 v48, v52, v53
    s_setprio 3
    s_waitcnt lgkmcnt(2)
    v_mfma_f32_32x32x16_bf16 v[80:95], v[64:67], v[224:227], v[80:95]
    ds_read_b64_tr_b16 v[72:73], v8 offset:49152
    ds_read_b64_tr_b16 v[74:75], v8 offset:49664
    v_mfma_f32_16x16x32_bf16 v[112:115], v[36:39], v[64:67], v[112:115]
    v_cvt_pk_bf16_f32 v49, v54, v55
    v_mul_f32 v56, v108, v108
    v_mul_f32 v57, v109, v109
    v_mul_f32 v58, v110, v110
    s_add_u32 s100, s98, 7
    s_and_b32 s100, s100, 3
    s_add_u32 s100, s100, s64
    s_add_u32 s100, s100, 4
    s_lshl_b32 s100, s100, 14
    s_add_u32 m0, s49, 69632
    s_add_u32 s100, s100, s90
    buffer_load_dwordx4 v17, s[12:15], s100 offen lds
    s_waitcnt lgkmcnt(2)
    v_mfma_f32_32x32x16_bf16 v[80:95], v[68:71], v[228:231], v[80:95]
    ds_read_b64_tr_b16 v[76:77], v9 offset:49152
    ds_read_b64_tr_b16 v[78:79], v9 offset:49664
    v_mul_f32 v59, v111, v111
    v_fma_f32 v56, v56, v26, v25
    v_fma_f32 v57, v57, v26, v25
    v_fma_f32 v58, v58, v26, v25
    s_setprio 2
    s_waitcnt lgkmcnt(2)
    v_mfma_f32_32x32x16_bf16 v[80:95], v[72:75], v[232:235], v[80:95]
    ds_read_b64_tr_b16 v[64:65], v6 offset:57344
    ds_read_b64_tr_b16 v[66:67], v6 offset:57856
    s_waitcnt vmcnt(12)
    v_mov_b32 v13, 1
    buffer_store_dword v13, v12, s[16:19], s51 offen sc1
    v_fma_f32 v59, v59, v26, v25
    v_mul_f32 v56, v108, v56
    v_mul_f32 v57, v109, v57
    v_mul_f32 v58, v110, v58
    s_add_u32 s100, s98, 8
    s_and_b32 s100, s100, 3
    s_add_u32 s100, s100, s64
    s_add_u32 s100, s100, 8
    s_lshl_b32 s100, s100, 14
    s_add_u32 m0, s49, 81920
    s_add_u32 s100, s100, s90
    buffer_load_dwordx4 v17, s[12:15], s100 offen lds
    s_waitcnt lgkmcnt(2)
    v_mfma_f32_32x32x16_bf16 v[80:95], v[76:79], v[236:239], v[80:95]
    ds_read_b64_tr_b16 v[68:69], v7 offset:57344
    ds_read_b64_tr_b16 v[70:71], v7 offset:57856
    v_mul_f32 v59, v111, v59
    v_exp_f32 v56, v56
    v_exp_f32 v57, v57
    v_exp_f32 v58, v58
    v_exp_f32 v59, v59
    s_setprio 1
    s_waitcnt lgkmcnt(2)
    v_mfma_f32_32x32x16_bf16 v[80:95], v[64:67], v[240:243], v[80:95]
    ds_read_b64_tr_b16 v[72:73], v8 offset:57344
    ds_read_b64_tr_b16 v[74:75], v8 offset:57856
    v_mfma_f32_16x16x32_bf16 v[112:115], v[36:39], v[64:67], v[112:115]
    v_fma_f32 v56, v56, v24, v24
    v_fma_f32 v57, v57, v24, v24
    v_fma_f32 v58, v58, v24, v24
    v_fma_f32 v59, v59, v24, v24
    s_add_u32 s100, s98, 9
    s_and_b32 s100, s100, 3
    s_add_u32 s100, s100, s64
    s_add_u32 s100, s100, 8
    s_lshl_b32 s100, s100, 14
    s_add_u32 m0, s49, 86016
    s_add_u32 s100, s100, s90
    buffer_load_dwordx4 v17, s[12:15], s100 offen lds
    s_waitcnt lgkmcnt(2)
    v_mfma_f32_32x32x16_bf16 v[80:95], v[68:71], v[244:247], v[80:95]
    ds_read_b64_tr_b16 v[76:77], v9 offset:57344
    ds_read_b64_tr_b16 v[78:79], v9 offset:57856
    v_add_u32 v113, s58, v0
    ds_write_b32 v113, v112 offset:2048
    v_rcp_f32 v56, v56
    v_rcp_f32 v57, v57
    v_rcp_f32 v58, v58
    v_rcp_f32 v59, v59
    s_setprio 0
    s_waitcnt lgkmcnt(3)
    v_mfma_f32_32x32x16_bf16 v[80:95], v[72:75], v[248:251], v[80:95]
    s_waitcnt vmcnt(9) lgkmcnt(0)
    s_barrier
    ds_read_b64_tr_b16 v[64:65], v10 offset:0
    ds_read_b64_tr_b16 v[66:67], v10 offset:256
    ds_read_b128 v[116:119], v0 offset:2048
    v_mul_f32 v56, v108, v56
    v_mul_f32 v57, v109, v57
    v_mul_f32 v58, v110, v58
    v_mul_f32 v59, v111, v59
    v_mfma_f32_32x32x16_bf16 v[80:95], v[76:79], v[252:255], v[80:95]
    ds_read_b64_tr_b16 v[68:69], v11 offset:0
    ds_read_b64_tr_b16 v[70:71], v11 offset:256
    v_cvt_pk_bf16_f32 v50, v56, v57
    v_cvt_pk_bf16_f32 v51, v58, v59
    buffer_store_dwordx4 v[44:47], v27, s[16:19], s62 offen offset:0 sc1
    buffer_store_dwordx4 v[48:51], v27, s[16:19], s62 offen offset:1024 sc1
    s_add_u32 s62, s62, 4096
    s_setprio 3
    s_waitcnt lgkmcnt(3)
    v_mfma_f32_32x32x16_bf16 v[96:111], v[64:67], v[128:131], 0
    ds_read_b64_tr_b16 v[72:73], v10 offset:4096
    ds_read_b64_tr_b16 v[74:75], v10 offset:4352
    v_mfma_f32_16x16x32_bf16 v[112:115], v[36:39], v[64:67], 0
    s_waitcnt lgkmcnt(4)
    v_add_f32 v22, v116, v117
    v_add_f32 v118, v118, v119
    v_add_f32 v22, v22, v118
    v_cvt_pk_bf16_f32 v32, v22, v22
    v_and_b32 v62, 0xffff0000, v32
    v_sub_f32 v62, v22, v62
    v_cvt_pk_bf16_f32 v62, v62, 0
    v_mov_b32 v34, v42
    v_lshl_or_b32 v33, v42, 16, v62
    s_nop 1
    v_mfma_f32_32x32x16_bf16 v[80:95], v[32:35], v[28:31], v[80:95]
    s_waitcnt lgkmcnt(2)
    v_mfma_f32_32x32x16_bf16 v[96:111], v[68:71], v[136:139], v[96:111]
    ds_read_b64_tr_b16 v[76:77], v11 offset:4096
    ds_read_b64_tr_b16 v[78:79], v11 offset:4352
    s_setprio 2
    s_waitcnt lgkmcnt(2)
    v_mfma_f32_32x32x16_bf16 v[96:111], v[72:75], v[144:147], v[96:111]
    ds_read_b64_tr_b16 v[64:65], v10 offset:8192
    ds_read_b64_tr_b16 v[66:67], v10 offset:8448
    v_mfma_f32_16x16x32_bf16 v[112:115], v[36:39], v[72:75], v[112:115]
    s_nop 1
    v_mul_f32 v52, v80, v80
    v_mul_f32 v53, v81, v81
    v_mul_f32 v54, v82, v82
    v_mul_f32 v55, v83, v83
    v_fma_f32 v52, v52, v26, v25
    v_fma_f32 v53, v53, v26, v25
    v_fma_f32 v54, v54, v26, v25
    v_fma_f32 v55, v55, v26, v25
    s_add_u32 s100, s98, 10
    s_and_b32 s100, s100, 3
    s_add_u32 s100, s100, s64
    s_add_u32 s100, s100, 8
    s_lshl_b32 s100, s100, 14
    s_add_u32 m0, s49, 98304
    s_add_u32 s100, s100, s90
    buffer_load_dwordx4 v17, s[12:15], s100 offen lds
    s_waitcnt lgkmcnt(2)
    v_mfma_f32_32x32x16_bf16 v[96:111], v[76:79], v[152:155], v[96:111]
    ds_read_b64_tr_b16 v[68:69], v11 offset:8192
    ds_read_b64_tr_b16 v[70:71], v11 offset:8448
    s_buffer_load_dwordx4 s[28:31], s[16:19], s44 offset:1024 glc
    v_mul_f32 v52, v80, v52
    v_mul_f32 v53, v81, v53
    v_mul_f32 v54, v82, v54
    v_mul_f32 v55, v83, v55
    v_exp_f32 v52, v52
    v_exp_f32 v53, v53
    v_exp_f32 v54, v54
    v_exp_f32 v55, v55
    v_fma_f32 v52, v52, v24, v24
    s_setprio 1
    s_waitcnt lgkmcnt(2)
    v_mfma_f32_32x32x16_bf16 v[96:111], v[64:67], v[160:163], v[96:111]
    ds_read_b64_tr_b16 v[72:73], v10 offset:12288
    ds_read_b64_tr_b16 v[74:75], v10 offset:12544
    v_mfma_f32_16x16x32_bf16 v[112:115], v[36:39], v[64:67], v[112:115]
    v_fma_f32 v53, v53, v24, v24
    v_fma_f32 v54, v54, v24, v24
    v_fma_f32 v55, v55, v24, v24
    v_rcp_f32 v52, v52
    v_rcp_f32 v53, v53
    v_rcp_f32 v54, v54
    v_rcp_f32 v55, v55
    v_mul_f32 v52, v80, v52
    s_add_u32 s100, s98, 11
    s_and_b32 s100, s100, 3
    s_add_u32 s100, s100, s64
    s_add_u32 s100, s100, 8
    s_lshl_b32 s100, s100, 14
    s_add_u32 m0, s49, 102400
    s_add_u32 s100, s100, s90
    buffer_load_dwordx4 v17, s[12:15], s100 offen lds
    s_waitcnt lgkmcnt(2)
    v_mfma_f32_32x32x16_bf16 v[96:111], v[68:71], v[168:171], v[96:111]
    ds_read_b64_tr_b16 v[76:77], v11 offset:12288
    ds_read_b64_tr_b16 v[78:79], v11 offset:12544
    v_mul_f32 v53, v81, v53
    v_mul_f32 v54, v82, v54
    v_mul_f32 v55, v83, v55
    v_cvt_pk_bf16_f32 v44, v52, v53
    v_cvt_pk_bf16_f32 v45, v54, v55
    v_mul_f32 v56, v84, v84
    v_mul_f32 v57, v85, v85
    v_mul_f32 v58, v86, v86
    v_mul_f32 v59, v87, v87
    s_setprio 0
    s_waitcnt lgkmcnt(2)
    v_mfma_f32_32x32x16_bf16 v[96:111], v[72:75], v[176:179], v[96:111]
    ds_read_b64_tr_b16 v[64:65], v10 offset:16384
    ds_read_b64_tr_b16 v[66:67], v10 offset:16640
    v_mfma_f32_16x16x32_bf16 v[112:115], v[36:39], v[72:75], v[112:115]
    v_fma_f32 v56, v56, v26, v25
    v_fma_f32 v57, v57, v26, v25
    v_fma_f32 v58, v58, v26, v25
    v_fma_f32 v59, v59, v26, v25
    v_mul_f32 v56, v84, v56
    v_mul_f32 v57, v85, v57
    v_mul_f32 v58, v86, v58
    v_mul_f32 v59, v87, v59
    s_waitcnt lgkmcnt(2)
    v_mfma_f32_32x32x16_bf16 v[96:111], v[76:79], v[184:187], v[96:111]
    ds_read_b64_tr_b16 v[68:69], v11 offset:16384
    ds_read_b64_tr_b16 v[70:71], v11 offset:16640
    v_exp_f32 v56, v56
    v_exp_f32 v57, v57
    v_exp_f32 v58, v58
    v_exp_f32 v59, v59
    v_fma_f32 v56, v56, v24, v24
    v_fma_f32 v57, v57, v24, v24
    v_fma_f32 v58, v58, v24, v24
    v_fma_f32 v59, v59, v24, v24
    v_rcp_f32 v56, v56
    s_setprio 3
    s_waitcnt lgkmcnt(2)
    v_mfma_f32_32x32x16_bf16 v[96:111], v[64:67], v[192:195], v[96:111]
    ds_read_b64_tr_b16 v[72:73], v10 offset:20480
    ds_read_b64_tr_b16 v[74:75], v10 offset:20736
    v_mfma_f32_16x16x32_bf16 v[112:115], v[36:39], v[64:67], v[112:115]
    v_rcp_f32 v57, v57
    v_rcp_f32 v58, v58
    v_rcp_f32 v59, v59
    v_mul_f32 v56, v84, v56
    v_mul_f32 v57, v85, v57
    v_mul_f32 v58, v86, v58
    v_mul_f32 v59, v87, v59
    v_cvt_pk_bf16_f32 v46, v56, v57
    v_cvt_pk_bf16_f32 v47, v58, v59
    s_waitcnt lgkmcnt(2)
    v_mfma_f32_32x32x16_bf16 v[96:111], v[68:71], v[200:203], v[96:111]
    ds_read_b64_tr_b16 v[76:77], v11 offset:20480
    ds_read_b64_tr_b16 v[78:79], v11 offset:20736
    v_mul_f32 v52, v88, v88
    v_mul_f32 v53, v89, v89
    v_mul_f32 v54, v90, v90
    v_mul_f32 v55, v91, v91
    v_fma_f32 v52, v52, v26, v25
    v_fma_f32 v53, v53, v26, v25
    v_fma_f32 v54, v54, v26, v25
    v_fma_f32 v55, v55, v26, v25
    s_mov_b32 s57, 0
L_sp_12:
    s_waitcnt lgkmcnt(0)
    s_min_u32 s28, s28, s29
    s_min_u32 s30, s30, s31
    s_min_u32 s28, s28, s30
    s_cmp_ge_u32 s28, 1
    s_cbranch_scc1 L_sp_12_ok
    s_add_u32 s57, s57, 1
    s_cmp_gt_u32 s57, 32768
    s_cbranch_scc1 L_sp_12_ok
    s_sleep 1
    s_buffer_load_dwordx4 s[28:31], s[16:19], s44 offset:1024 glc
    s_branch L_sp_12
L_sp_12_ok:
    s_buffer_load_dwordx4 s[28:31], s[16:19], s44 offset:0 glc
    s_setprio 2
    v_mfma_f32_32x32x16_bf16 v[96:111], v[72:75], v[208:211], v[96:111]
    ds_read_b64_tr_b16 v[64:65], v10 offset:24576
    ds_read_b64_tr_b16 v[66:67], v10 offset:24832
    v_mfma_f32_16x16x32_bf16 v[112:115], v[36:39], v[72:75], v[112:115]
    v_mul_f32 v52, v88, v52
    v_mul_f32 v53, v89, v53
    v_mul_f32 v54, v90, v54
    v_mul_f32 v55, v91, v55
    v_exp_f32 v52, v52
    v_exp_f32 v53, v53
    v_exp_f32 v54, v54
    v_exp_f32 v55, v55
    v_fma_f32 v52, v52, v24, v24
    s_add_u32 s101, s98, 0
    s_and_b32 s101, s101, 3
    s_add_u32 s101, s101, s64
    s_lshl_b32 s101, s101, 10
    s_add_u32 s101, s101, s96
    buffer_load_dwordx4 v[132:135], v27, s[16:19], s101 offen sc1
    v_mfma_f32_32x32x16_bf16 v[96:111], v[76:79], v[216:219], v[96:111]
    ds_read_b64_tr_b16 v[68:69], v11 offset:24576
    ds_read_b64_tr_b16 v[70:71], v11 offset:24832
    v_fma_f32 v53, v53, v24, v24
    v_fma_f32 v54, v54, v24, v24
    v_fma_f32 v55, v55, v24, v24
    v_rcp_f32 v52, v52
    v_rcp_f32 v53, v53
    v_rcp_f32 v54, v54
    v_rcp_f32 v55, v55
    v_mul_f32 v52, v88, v52
    s_add_u32 s101, s98, 1
    s_and_b32 s101, s101, 3
    s_add_u32 s101, s101, s64
    s_lshl_b32 s101, s101, 10
    s_add_u32 s101, s101, s96
    buffer_load_dwordx4 v[140:143], v27, s[16:19], s101 offen sc1
    s_setprio 1
    s_waitcnt lgkmcnt(2)
    v_mfma_f32_32x32x16_bf16 v[96:111], v[64:67], v[224:227], v[96:111]
    ds_read_b64_tr_b16 v[72:73], v10 offset:28672
    ds_read_b64_tr_b16 v[74:75], v10 offset:28928
    v_mfma_f32_16x16x32_bf16 v[112:115], v[36:39], v[64:67], v[112:115]
    v_mul_f32 v53, v89, v53
    v_mul_f32 v54, v90, v54
    v_mul_f32 v55, v91, v55
    v_cvt_pk_bf16_f32 v48, v52, v53
    v_cvt_pk_bf16_f32 v49, v54, v55
    v_mul_f32 v56, v92, v92
    v_mul_f32 v57, v93, v93
    v_mul_f32 v58, v94, v94
    v_mul_f32 v59, v95, v95
    s_add_u32 s101, s98, 2
    s_and_b32 s101, s101, 3
    s_add_u32 s101, s101, s64
    s_lshl_b32 s101, s101, 10
    s_add_u32 s101, s101, s96
    buffer_load_dwordx4 v[148:151], v27, s[16:19], s101 offen sc1
    s_waitcnt lgkmcnt(2)
    v_mfma_f32_32x32x16_bf16 v[96:111], v[68:71], v[232:235], v[96:111]
    ds_read_b64_tr_b16 v[76:77], v11 offset:28672
    ds_read_b64_tr_b16 v[78:79], v11 offset:28928
    v_fma_f32 v56, v56, v26, v25
    v_fma_f32 v57, v57, v26, v25
    v_fma_f32 v58, v58, v26, v25
    v_fma_f32 v59, v59, v26, v25
    v_mul_f32 v56, v92, v56
    v_mul_f32 v57, v93, v57
    v_mul_f32 v58, v94, v58
    v_mul_f32 v59, v95, v59
    s_add_u32 s101, s98, 3
    s_and_b32 s101, s101, 3
    s_add_u32 s101, s101, s64
    s_lshl_b32 s101, s101, 10
    s_add_u32 s101, s101, s96
    buffer_load_dwordx4 v[156:159], v27, s[16:19], s101 offen sc1
    s_setprio 0
    s_waitcnt lgkmcnt(2)
    v_mfma_f32_32x32x16_bf16 v[96:111], v[72:75], v[240:243], v[96:111]
    v_mfma_f32_16x16x32_bf16 v[112:115], v[36:39], v[72:75], v[112:115]
    v_exp_f32 v56, v56
    v_exp_f32 v57, v57
    v_exp_f32 v58, v58
    v_exp_f32 v59, v59
    v_fma_f32 v56, v56, v24, v24
    v_fma_f32 v57, v57, v24, v24
    v_fma_f32 v58, v58, v24, v24
    v_fma_f32 v59, v59, v24, v24
    v_rcp_f32 v56, v56
    s_waitcnt lgkmcnt(0)
    v_mfma_f32_32x32x16_bf16 v[96:111], v[76:79], v[248:251], v[96:111]
    v_rcp_f32 v57, v57
    v_rcp_f32 v58, v58
    v_rcp_f32 v59, v59
    v_mul_f32 v56, v92, v56
    v_mul_f32 v57, v93, v57
    v_mul_f32 v58, v94, v58
    v_mul_f32 v59, v95, v59
    v_cvt_pk_bf16_f32 v50, v56, v57
    v_cvt_pk_bf16_f32 v51, v58, v59
    s_setprio 0
    v_and_b32 v60, 31, v1
    s_lshl_b32 s47, s52, 4
    v_xor_b32 v60, s47, v60
    v_lshlrev_b32 v60, 4, v60
    v_add_u32 v60, 158720, v60
    v_add_u32 v61, s58, v0
    ds_write_b32 v61, v112 offset:3072
    s_add_u32 s48, s49, 114688
    s_xor_b32 s47, s48, 8192
    v_add_u32 v61, s47, v27
    v_add_u32 v10, s48, v27
    ds_write_b128 v61, v[104:107]
    ds_write_b128 v61, v[108:111] offset:4096
    s_waitcnt vmcnt(4) lgkmcnt(0)
    s_barrier
    ds_read_b128 v[116:119], v60
    ds_read_b128 v[80:83], v10
    ds_read_b128 v[84:87], v10 offset:4096
    s_waitcnt lgkmcnt(2)
    v_add_f32 v22, v116, v117
    v_add_f32 v118, v118, v119
    v_add_f32 v22, v22, v118
    v_cvt_pk_bf16_f32 v32, v22, v22
    v_and_b32 v62, 0xffff0000, v32
    v_sub_f32 v62, v22, v62
    v_cvt_pk_bf16_f32 v62, v62, 0
    v_mov_b32 v34, v43
    v_lshl_or_b32 v33, v43, 16, v62
    s_nop 1
    v_mfma_f32_32x32x16_bf16 v[96:111], v[32:35], v[28:31], v[96:111]
    v_mov_b32 v13, 2
    buffer_store_dword v13, v12, s[16:19], s51 offen sc1
    s_waitcnt lgkmcnt(1)
    s_nop 8
    v_pk_add_f32 v[96:97], v[96:97], v[80:81]
    v_pk_add_f32 v[98:99], v[98:99], v[82:83]
    s_waitcnt lgkmcnt(0)
    v_pk_add_f32 v[100:101], v[100:101], v[84:85]
    v_pk_add_f32 v[102:103], v[102:103], v[86:87]
    s_mov_b32 s57, 0
L_sp_13:
    s_waitcnt lgkmcnt(0)
    s_min_u32 s28, s28, s29
    s_min_u32 s30, s30, s31
    s_min_u32 s28, s28, s30
    s_cmp_ge_u32 s28, 1
    s_cbranch_scc1 L_sp_13_ok
    s_add_u32 s57, s57, 1
    s_cmp_gt_u32 s57, 32768
    s_cbranch_scc1 L_sp_13_ok
    s_sleep 1
    s_buffer_load_dwordx4 s[28:31], s[16:19], s44 offset:0 glc
    s_branch L_sp_13
L_sp_13_ok:
    v_pk_mul_f32 v[52:53], v[96:97], v[96:97]
    v_pk_mul_f32 v[54:55], v[98:99], v[98:99]
    v_pk_fma_f32 v[52:53], v[52:53], v[26:27], v[24:25] op_sel:[0,0,1] op_sel_hi:[1,0,1]
    v_pk_fma_f32 v[54:55], v[54:55], v[26:27], v[24:25] op_sel:[0,0,1] op_sel_hi:[1,0,1]
    v_pk_mul_f32 v[52:53], v[96:97], v[52:53]
    v_pk_mul_f32 v[54:55], v[98:99], v[54:55]
    v_exp_f32 v52, v52
    v_exp_f32 v53, v53
    v_exp_f32 v54, v54
    v_exp_f32 v55, v55
    v_pk_fma_f32 v[52:53], v[52:53], v[24:25], v[24:25] op_sel_hi:[1,0,0]
    v_pk_fma_f32 v[54:55], v[54:55], v[24:25], v[24:25] op_sel_hi:[1,0,0]
    v_rcp_f32 v52, v52
    v_rcp_f32 v53, v53
    v_rcp_f32 v54, v54
    v_rcp_f32 v55, v55
    v_pk_mul_f32 v[52:53], v[96:97], v[52:53]
    v_pk_mul_f32 v[54:55], v[98:99], v[54:55]
    v_cvt_pk_bf16_f32 v40, v52, v53
    v_cvt_pk_bf16_f32 v41, v54, v55
    buffer_store_dwordx4 v[44:47], v27, s[16:19], s62 offen offset:0 sc1
    v_pk_mul_f32 v[56:57], v[100:101], v[100:101]
    v_pk_mul_f32 v[58:59], v[102:103], v[102:103]
    v_pk_fma_f32 v[56:57], v[56:57], v[26:27], v[24:25] op_sel:[0,0,1] op_sel_hi:[1,0,1]
    v_pk_fma_f32 v[58:59], v[58:59], v[26:27], v[24:25] op_sel:[0,0,1] op_sel_hi:[1,0,1]
    v_pk_mul_f32 v[56:57], v[100:101], v[56:57]
    v_pk_mul_f32 v[58:59], v[102:103], v[58:59]
    v_exp_f32 v56, v56
    v_exp_f32 v57, v57
    v_exp_f32 v58, v58
    v_exp_f32 v59, v59
    buffer_store_dwordx4 v[48:51], v27, s[16:19], s62 offen offset:1024 sc1
    v_pk_fma_f32 v[56:57], v[56:57], v[24:25], v[24:25] op_sel_hi:[1,0,0]
    v_pk_fma_f32 v[58:59], v[58:59], v[24:25], v[24:25] op_sel_hi:[1,0,0]
    v_rcp_f32 v56, v56
    v_rcp_f32 v57, v57
    v_rcp_f32 v58, v58
    v_rcp_f32 v59, v59
    v_pk_mul_f32 v[56:57], v[100:101], v[56:57]
    v_pk_mul_f32 v[58:59], v[102:103], v[58:59]
    v_cvt_pk_bf16_f32 v42, v56, v57
    v_cvt_pk_bf16_f32 v43, v58, v59
    buffer_store_dwordx4 v[40:43], v27, s[16:19], s63 offen offset:0 sc1
    v_bfe_u32 v52, v1, 2, 2
    v_lshrrev_b32 v53, 5, v1
    v_and_b32 v54, 63, v6
    s_lshl_b32 s47, s52, 5
    v_xor_b32 v54, s47, v54
    v_lshl_add_u32 v55, v53, 2, v52
    v_lshl_add_u32 v55, v55, 8, v54
    s_lshl_b32 s47, s52, 13
    v_add_u32 v55, s47, v55
    v_xor_b32 v52, s6, v52
    v_lshl_add_u32 v2, v52, 6, v55
    v_xor_b32 v3, 64, v2
    v_xor_b32 v4, 128, v2
    v_xor_b32 v5, 192, v2
    v_add_u32 v10, 131072, v2
    v_add_u32 v11, 131072, v3
    v_add_u32 v14, 131072, v4
    v_add_u32 v15, 131072, v5
    v_add_u32 v6, 65536, v2
    v_add_u32 v7, 65536, v3
    v_add_u32 v8, 65536, v4
    v_add_u32 v9, 65536, v5
    ds_read_b64_tr_b16 v[128:129], v10 offset:0
    ds_read_b64_tr_b16 v[130:131], v10 offset:2048
    ds_read_b64_tr_b16 v[136:137], v11 offset:0
    ds_read_b64_tr_b16 v[138:139], v11 offset:2048
    ds_read_b64_tr_b16 v[144:145], v14 offset:0
    ds_read_b64_tr_b16 v[146:147], v14 offset:2048
    ds_read_b64_tr_b16 v[152:153], v15 offset:0
    ds_read_b64_tr_b16 v[154:155], v15 offset:2048
    s_setprio 3
    s_waitcnt vmcnt(7) lgkmcnt(6)
    v_mfma_f32_32x32x16_bf16 v[64:79], v[128:131], v[132:135], 0
    ds_read_b64_tr_b16 v[160:161], v10 offset:4096
    ds_read_b64_tr_b16 v[162:163], v10 offset:6144
    s_mul_i32 s100, s64, 6
    s_sub_u32 s100, 12, s100
    s_lshl_b32 s100, s100, 14
    s_add_u32 m0, s49, 0
    s_add_u32 s100, s100, s90
    buffer_load_dwordx4 v17, s[12:15], s100 offen lds
    s_buffer_load_dwordx4 s[28:31], s[16:19], s44 offset:1024 glc
    s_waitcnt lgkmcnt(6)
    v_mfma_f32_32x32x16_bf16 v[80:95], v[136:139], v[132:135], 0
    ds_read_b64_tr_b16 v[168:169], v11 offset:4096
    ds_read_b64_tr_b16 v[170:171], v11 offset:6144
    s_mul_i32 s100, s64, 6
    s_sub_u32 s100, 13, s100
    s_lshl_b32 s100, s100, 14
    s_add_u32 m0, s49, 4096
    s_add_u32 s100, s100, s90
    buffer_load_dwordx4 v17, s[12:15], s100 offen lds
    s_waitcnt lgkmcnt(6)
    v_mfma_f32_32x32x16_bf16 v[96:111], v[144:147], v[132:135], 0
    ds_read_b64_tr_b16 v[176:177], v14 offset:4096
    ds_read_b64_tr_b16 v[178:179], v14 offset:6144
    s_add_u32 s100, s98, 0
    s_and_b32 s100, s100, 3
    s_lshl_b32 s100, s100, 14
    s_add_u32 m0, s49, 16384
    s_add_u32 s100, s100, s91
    buffer_load_dwordx4 v17, s[36:39], s100 offen lds
    s_waitcnt lgkmcnt(6)
    v_mfma_f32_32x32x16_bf16 v[112:127], v[152:155], v[132:135], 0
    ds_read_b64_tr_b16 v[184:185], v15 offset:4096
    ds_read_b64_tr_b16 v[186:187], v15 offset:6144
    s_add_u32 s100, s98, 1
    s_and_b32 s100, s100, 3
    s_lshl_b32 s100, s100, 14
    s_add_u32 m0, s49, 20480
    s_add_u32 s100, s100, s91
    buffer_load_dwordx4 v17, s[36:39], s100 offen lds
    s_setprio 2
    s_waitcnt vmcnt(10) lgkmcnt(6)
    v_mfma_f32_32x32x16_bf16 v[64:79], v[160:163], v[140:143], v[64:79]
    ds_read_b64_tr_b16 v[128:129], v3 offset:32768
    ds_read_b64_tr_b16 v[130:131], v3 offset:34816
    s_add_u32 s100, s98, 2
    s_and_b32 s100, s100, 3
    s_lshl_b32 s100, s100, 14
    s_add_u32 m0, s49, 114688
    s_add_u32 s100, s100, s91
    buffer_load_dwordx4 v17, s[36:39], s100 offen lds
    s_waitcnt lgkmcnt(6)
    v_mfma_f32_32x32x16_bf16 v[80:95], v[168:171], v[140:143], v[80:95]
    ds_read_b64_tr_b16 v[136:137], v4 offset:32768
    ds_read_b64_tr_b16 v[138:139], v4 offset:34816
    s_add_u32 s100, s98, 3
    s_and_b32 s100, s100, 3
    s_lshl_b32 s100, s100, 14
    s_add_u32 m0, s49, 118784
    s_add_u32 s100, s100, s91
    buffer_load_dwordx4 v17, s[36:39], s100 offen lds
    s_waitcnt vmcnt(6)
    v_mov_b32 v13, 3
    buffer_store_dword v13, v12, s[16:19], s51 offen sc1
    s_waitcnt lgkmcnt(6)
    v_mfma_f32_32x32x16_bf16 v[96:111], v[176:179], v[140:143], v[96:111]
    ds_read_b64_tr_b16 v[144:145], v5 offset:32768
    ds_read_b64_tr_b16 v[146:147], v5 offset:34816
    s_waitcnt lgkmcnt(6)
    v_mfma_f32_32x32x16_bf16 v[112:127], v[184:187], v[140:143], v[112:127]
    ds_read_b64_tr_b16 v[152:153], v3 offset:36864
    ds_read_b64_tr_b16 v[154:155], v3 offset:38912
    s_mov_b32 s57, 0
L_sp_14:
    s_waitcnt lgkmcnt(0)
    s_min_u32 s28, s28, s29
    s_min_u32 s30, s30, s31
    s_min_u32 s28, s28, s30
    s_cmp_ge_u32 s28, 2
    s_cbranch_scc1 L_sp_14_ok
    s_add_u32 s57, s57, 1
    s_cmp_gt_u32 s57, 32768
    s_cbranch_scc1 L_sp_14_ok
    s_sleep 1
    s_buffer_load_dwordx4 s[28:31], s[16:19], s44 offset:1024 glc
    s_branch L_sp_14
L_sp_14_ok:
    s_add_u32 s101, s98, 4
    s_and_b32 s101, s101, 3
    s_add_u32 s101, s101, s64
    s_add_u32 s101, s101, 4
    s_lshl_b32 s101, s101, 10
    s_add_u32 s101, s101, s96
    buffer_load_dwordx4 v[164:167], v27, s[16:19], s101 offen sc1
    s_setprio 1
    v_mfma_f32_32x32x16_bf16 v[80:95], v[128:131], v[148:151], v[80:95]
    ds_read_b64_tr_b16 v[160:161], v4 offset:36864
    ds_read_b64_tr_b16 v[162:163], v4 offset:38912
    s_add_u32 s101, s98, 5
    s_and_b32 s101, s101, 3
    s_add_u32 s101, s101, s64
    s_add_u32 s101, s101, 4
    s_lshl_b32 s101, s101, 10
    s_add_u32 s101, s101, s96
    buffer_load_dwordx4 v[172:175], v27, s[16:19], s101 offen sc1
    v_mfma_f32_32x32x16_bf16 v[96:111], v[136:139], v[148:151], v[96:111]
    ds_read_b64_tr_b16 v[168:169], v5 offset:36864
    ds_read_b64_tr_b16 v[170:171], v5 offset:38912
    s_add_u32 s101, s98, 6
    s_and_b32 s101, s101, 3
    s_add_u32 s101, s101, s64
    s_add_u32 s101, s101, 4
    s_lshl_b32 s101, s101, 10
    s_add_u32 s101, s101, s96
    buffer_load_dwordx4 v[180:183], v27, s[16:19], s101 offen sc1
    v_and_b32 v61, 31, v1
    v_lshrrev_b32 v62, 5, v1
    v_lshlrev_b32 v62, 4, v62
    v_lshl_add_u32 v16, v61, 10, v62
    buffer_load_dwordx4 v[32:35], v16, s[8:11], s45 offen
    buffer_load_dwordx4 v[36:39], v62, s[92:95], s7 offen
    v_mfma_f32_32x32x16_bf16 v[112:127], v[144:147], v[148:151], v[112:127]
    ds_read_b64_tr_b16 v[176:177], v3 offset:49152
    ds_read_b64_tr_b16 v[178:179], v3 offset:51200
    s_add_u32 s101, s98, 7
    s_and_b32 s101, s101, 3
    s_add_u32 s101, s101, s64
    s_add_u32 s101, s101, 4
    s_lshl_b32 s101, s101, 10
    s_add_u32 s101, s101, s96
    buffer_load_dwordx4 v[188:191], v27, s[16:19], s101 offen sc1
    v_mfma_f32_32x32x16_bf16 v[80:95], v[152:155], v[156:159], v[80:95]
    ds_read_b64_tr_b16 v[184:185], v4 offset:49152
    ds_read_b64_tr_b16 v[186:187], v4 offset:51200
    v_mov_b32 v28, -1
    v_mov_b32 v29, -1
    v_mov_b32 v30, -1
    v_mov_b32 v31, -1
    s_setprio 0
    s_waitcnt lgkmcnt(6)
    v_mfma_f32_32x32x16_bf16 v[96:111], v[160:163], v[156:159], v[96:111]
    ds_read_b64_tr_b16 v[128:129], v5 offset:49152
    ds_read_b64_tr_b16 v[130:131], v5 offset:51200
    s_xor_b32 s47, s2, 1
    s_mul_i32 s47, s47, 24576
    s_lshl_b32 s48, s3, 10
    s_add_u32 s47, s47, s48
    s_add_u32 s47, s47, 16777216
    buffer_store_dwordx4 v[28:31], v27, s[16:19], s47 offen sc1
    s_waitcnt lgkmcnt(6)
    v_mfma_f32_32x32x16_bf16 v[112:127], v[168:171], v[156:159], v[112:127]
    ds_read_b64_tr_b16 v[136:137], v3 offset:53248
    ds_read_b64_tr_b16 v[138:139], v3 offset:55296
    s_buffer_load_dwordx4 s[28:31], s[16:19], s44 offset:1024 glc
    s_xor_b32 s47, s2, 2
    s_mul_i32 s47, s47, 24576
    s_lshl_b32 s48, s3, 10
    s_add_u32 s47, s47, s48
    s_add_u32 s47, s47, 16785408
    buffer_store_dwordx4 v[28:31], v27, s[16:19], s47 offen sc1
    s_waitcnt vmcnt(7) lgkmcnt(6)
    v_mfma_f32_32x32x16_bf16 v[80:95], v[176:179], v[164:167], v[80:95]
    ds_read_b64_tr_b16 v[144:145], v4 offset:53248
    ds_read_b64_tr_b16 v[146:147], v4 offset:55296
    s_xor_b32 s47, s2, 3
    s_mul_i32 s47, s47, 24576
    s_lshl_b32 s48, s3, 10
    s_add_u32 s47, s47, s48
    s_add_u32 s47, s47, 16793600
    buffer_store_dwordx4 v[28:31], v27, s[16:19], s47 offen sc1
    s_waitcnt lgkmcnt(6)
    v_mfma_f32_32x32x16_bf16 v[96:111], v[184:187], v[164:167], v[96:111]
    ds_read_b64_tr_b16 v[152:153], v5 offset:53248
    ds_read_b64_tr_b16 v[154:155], v5 offset:55296
    s_setprio 3
    s_waitcnt lgkmcnt(6)
    v_mfma_f32_32x32x16_bf16 v[112:127], v[128:131], v[164:167], v[112:127]
    ds_read_b64_tr_b16 v[160:161], v7 offset:0
    ds_read_b64_tr_b16 v[162:163], v7 offset:2048
    s_waitcnt vmcnt(7) lgkmcnt(6)
    v_mfma_f32_32x32x16_bf16 v[80:95], v[136:139], v[172:175], v[80:95]
    ds_read_b64_tr_b16 v[168:169], v8 offset:0
    ds_read_b64_tr_b16 v[170:171], v8 offset:2048
    s_mov_b32 s57, 0
L_sp_15:
    s_waitcnt lgkmcnt(0)
    s_min_u32 s28, s28, s29
    s_min_u32 s30, s30, s31
    s_min_u32 s28, s28, s30
    s_cmp_ge_u32 s28, 3
    s_cbranch_scc1 L_sp_15_ok
    s_add_u32 s57, s57, 1
    s_cmp_gt_u32 s57, 32768
    s_cbranch_scc1 L_sp_15_ok
    s_sleep 1
    s_buffer_load_dwordx4 s[28:31], s[16:19], s44 offset:1024 glc
    s_branch L_sp_15
L_sp_15_ok:
    s_add_u32 s101, s98, 8
    s_and_b32 s101, s101, 3
    s_add_u32 s101, s101, s64
    s_add_u32 s101, s101, 8
    s_lshl_b32 s101, s101, 10
    s_add_u32 s101, s101, s96
    buffer_load_dwordx4 v[196:199], v27, s[16:19], s101 offen sc1
    v_mfma_f32_32x32x16_bf16 v[96:111], v[144:147], v[172:175], v[96:111]
    ds_read_b64_tr_b16 v[176:177], v9 offset:0
    ds_read_b64_tr_b16 v[178:179], v9 offset:2048
    s_add_u32 s101, s98, 9
    s_and_b32 s101, s101, 3
    s_add_u32 s101, s101, s64
    s_add_u32 s101, s101, 8
    s_lshl_b32 s101, s101, 10
    s_add_u32 s101, s101, s96
    buffer_load_dwordx4 v[204:207], v27, s[16:19], s101 offen sc1
    v_mfma_f32_32x32x16_bf16 v[112:127], v[152:155], v[172:175], v[112:127]
    ds_read_b64_tr_b16 v[184:185], v7 offset:4096
    ds_read_b64_tr_b16 v[186:187], v7 offset:6144
    s_add_u32 s101, s98, 10
    s_and_b32 s101, s101, 3
    s_add_u32 s101, s101, s64
    s_add_u32 s101, s101, 8
    s_lshl_b32 s101, s101, 10
    s_add_u32 s101, s101, s96
    buffer_load_dwordx4 v[212:215], v27, s[16:19], s101 offen sc1
    s_setprio 2
    s_waitcnt vmcnt(9)
    v_mfma_f32_32x32x16_bf16 v[80:95], v[160:163], v[180:183], v[80:95]
    ds_read_b64_tr_b16 v[128:129], v8 offset:4096
    ds_read_b64_tr_b16 v[130:131], v8 offset:6144
    s_add_u32 s101, s98, 11
    s_and_b32 s101, s101, 3
    s_add_u32 s101, s101, s64
    s_add_u32 s101, s101, 8
    s_lshl_b32 s101, s101, 10
    s_add_u32 s101, s101, s96
    buffer_load_dwordx4 v[220:223], v27, s[16:19], s101 offen sc1
    v_mfma_f32_32x32x16_bf16 v[96:111], v[168:171], v[180:183], v[96:111]
    ds_read_b64_tr_b16 v[136:137], v9 offset:4096
    ds_read_b64_tr_b16 v[138:139], v9 offset:6144
    s_mul_i32 s101, s64, 6
    s_sub_u32 s101, 12, s101
    s_lshl_b32 s101, s101, 10
    s_add_u32 s101, s101, s96
    buffer_load_dwordx4 v[228:231], v27, s[16:19], s101 offen sc1
    s_waitcnt lgkmcnt(6)
    v_mfma_f32_32x32x16_bf16 v[112:127], v[176:179], v[180:183], v[112:127]
    ds_read_b64_tr_b16 v[144:145], v7 offset:16384
    ds_read_b64_tr_b16 v[146:147], v7 offset:18432
    s_mul_i32 s101, s64, 6
    s_sub_u32 s101, 13, s101
    s_lshl_b32 s101, s101, 10
    s_add_u32 s101, s101, s96
    buffer_load_dwordx4 v[236:239], v27, s[16:19], s101 offen sc1
    s_waitcnt vmcnt(9) lgkmcnt(6)
    v_mfma_f32_32x32x16_bf16 v[80:95], v[184:187], v[188:191], v[80:95]
    ds_read_b64_tr_b16 v[152:153], v8 offset:16384
    ds_read_b64_tr_b16 v[154:155], v8 offset:18432
    s_setprio 1
    s_waitcnt lgkmcnt(6)
    v_mfma_f32_32x32x16_bf16 v[96:111], v[128:131], v[188:191], v[96:111]
    ds_read_b64_tr_b16 v[160:161], v9 offset:16384
    ds_read_b64_tr_b16 v[162:163], v9 offset:18432
    s_add_u32 s101, s98, 0
    s_and_b32 s101, s101, 3
    s_lshl_b32 s101, s101, 10
    s_add_u32 s101, s101, s97
    buffer_load_dwordx4 v[244:247], v27, s[16:19], s101 offen sc1
    v_add_u32 v20, s46, v27
    v_xor_b32 v23, 8192, v20
    v_add_u32 v21, 65536, v20
    v_add_u32 v24, 65536, v23
    v_add_u32 v22, 131072, v20
    v_add_u32 v25, 131072, v23
    s_waitcnt lgkmcnt(6)
    v_mfma_f32_32x32x16_bf16 v[112:127], v[136:139], v[188:191], v[112:127]
    ds_read_b64_tr_b16 v[168:169], v7 offset:20480
    ds_read_b64_tr_b16 v[170:171], v7 offset:22528
    s_add_u32 s101, s98, 1
    s_and_b32 s101, s101, 3
    s_lshl_b32 s101, s101, 10
    s_add_u32 s101, s101, s97
    buffer_load_dwordx4 v[252:255], v27, s[16:19], s101 offen sc1
    s_waitcnt vmcnt(7) lgkmcnt(6)
    v_mfma_f32_32x32x16_bf16 v[80:95], v[144:147], v[196:199], v[80:95]
    ds_read_b64_tr_b16 v[176:177], v8 offset:20480
    ds_read_b64_tr_b16 v[178:179], v8 offset:22528
    s_add_u32 s101, s98, 2
    s_and_b32 s101, s101, 3
    s_lshl_b32 s101, s101, 10
    s_add_u32 s101, s101, s97
    buffer_load_dwordx4 v[132:135], v27, s[16:19], s101 offen sc1
    s_waitcnt lgkmcnt(6)
    v_mfma_f32_32x32x16_bf16 v[96:111], v[152:155], v[196:199], v[96:111]
    ds_read_b64_tr_b16 v[184:185], v9 offset:20480
    ds_read_b64_tr_b16 v[186:187], v9 offset:22528
    s_add_u32 s101, s98, 3
    s_and_b32 s101, s101, 3
    s_lshl_b32 s101, s101, 10
    s_add_u32 s101, s101, s97
    buffer_load_dwordx4 v[140:143], v27, s[16:19], s101 offen sc1
    s_setprio 0
    s_waitcnt lgkmcnt(6)
    v_mfma_f32_32x32x16_bf16 v[112:127], v[160:163], v[196:199], v[112:127]
    ds_read_b64_tr_b16 v[128:129], v7 offset:32768
    ds_read_b64_tr_b16 v[130:131], v7 offset:34816
    s_waitcnt vmcnt(8) lgkmcnt(6)
    v_mfma_f32_32x32x16_bf16 v[80:95], v[168:171], v[204:207], v[80:95]
    ds_read_b64_tr_b16 v[136:137], v8 offset:32768
    ds_read_b64_tr_b16 v[138:139], v8 offset:34816
    s_waitcnt lgkmcnt(6)
    v_mfma_f32_32x32x16_bf16 v[96:111], v[176:179], v[204:207], v[96:111]
    ds_read_b64_tr_b16 v[144:145], v9 offset:32768
    ds_read_b64_tr_b16 v[146:147], v9 offset:34816
    s_waitcnt lgkmcnt(6)
    v_mfma_f32_32x32x16_bf16 v[112:127], v[184:187], v[204:207], v[112:127]
    ds_read_b64_tr_b16 v[152:153], v7 offset:36864
    ds_read_b64_tr_b16 v[154:155], v7 offset:38912
    s_setprio 3
    s_waitcnt vmcnt(7) lgkmcnt(6)
    v_mfma_f32_32x32x16_bf16 v[80:95], v[128:131], v[212:215], v[80:95]
    ds_read_b64_tr_b16 v[160:161], v8 offset:36864
    ds_read_b64_tr_b16 v[162:163], v8 offset:38912
    s_waitcnt lgkmcnt(6)
    v_mfma_f32_32x32x16_bf16 v[96:111], v[136:139], v[212:215], v[96:111]
    ds_read_b64_tr_b16 v[168:169], v9 offset:36864
    ds_read_b64_tr_b16 v[170:171], v9 offset:38912
    s_waitcnt lgkmcnt(6)
    v_mfma_f32_32x32x16_bf16 v[112:127], v[144:147], v[212:215], v[112:127]
    s_barrier
    ds_read_b64_tr_b16 v[176:177], v3 offset:0
    ds_read_b64_tr_b16 v[178:179], v3 offset:2048
    s_waitcnt vmcnt(6) lgkmcnt(6)
    v_mfma_f32_32x32x16_bf16 v[80:95], v[152:155], v[220:223], v[80:95]
    ds_read_b64_tr_b16 v[184:185], v3 offset:4096
    ds_read_b64_tr_b16 v[186:187], v3 offset:6144
    s_setprio 2
    s_waitcnt lgkmcnt(6)
    v_mfma_f32_32x32x16_bf16 v[96:111], v[160:163], v[220:223], v[96:111]
    ds_read_b64_tr_b16 v[128:129], v3 offset:16384
    ds_read_b64_tr_b16 v[130:131], v3 offset:18432
    s_waitcnt lgkmcnt(6)
    v_mfma_f32_32x32x16_bf16 v[112:127], v[168:171], v[220:223], v[112:127]
    ds_read_b64_tr_b16 v[136:137], v3 offset:20480
    ds_read_b64_tr_b16 v[138:139], v3 offset:22528
    s_waitcnt vmcnt(5) lgkmcnt(6)
    v_mfma_f32_32x32x16_bf16 v[80:95], v[176:179], v[228:231], v[80:95]
    ds_read_b64_tr_b16 v[144:145], v7 offset:49152
    ds_read_b64_tr_b16 v[146:147], v7 offset:51200
    s_waitcnt vmcnt(3)
    v_max3_u32 v60, v244, v245, v246
    v_max_u32 v60, v60, v247
    v_cmp_eq_u32 vcc, -1, v60
    s_nop 0
    s_cbranch_vccnz L_v_16_slow
L_v_16_back:
    s_waitcnt lgkmcnt(6)
    v_mfma_f32_32x32x16_bf16 v[80:95], v[184:187], v[236:239], v[80:95]
    ds_read_b64_tr_b16 v[152:153], v7 offset:53248
    ds_read_b64_tr_b16 v[154:155], v7 offset:55296
    s_waitcnt vmcnt(2)
    v_max3_u32 v60, v252, v253, v254
    v_max_u32 v60, v60, v255
    v_cmp_eq_u32 vcc, -1, v60
    s_nop 0
    s_cbranch_vccnz L_v_17_slow
L_v_17_back:
    s_setprio 1
    s_waitcnt lgkmcnt(6)
    v_mfma_f32_32x32x16_bf16 v[80:95], v[128:131], v[244:247], v[80:95]
    ds_read_b64_tr_b16 v[160:161], v4 offset:0
    ds_read_b64_tr_b16 v[162:163], v4 offset:2048
    s_waitcnt vmcnt(1)
    v_max3_u32 v60, v132, v133, v134
    v_max_u32 v60, v60, v135
    v_cmp_eq_u32 vcc, -1, v60
    s_nop 0
    s_cbranch_vccnz L_v_18_slow
L_v_18_back:
    v_lshlrev_b32 v52, 16, v32
    v_and_b32 v53, 0xffff0000, v32
    v_lshlrev_b32 v48, 16, v36
    v_and_b32 v49, 0xffff0000, v36
    v_add_f32 v52, v52, v48
    v_add_f32 v53, v53, v49
    s_waitcnt lgkmcnt(6)
    v_mfma_f32_32x32x16_bf16 v[80:95], v[136:139], v[252:255], v[80:95]
    ds_read_b64_tr_b16 v[168:169], v4 offset:4096
    ds_read_b64_tr_b16 v[170:171], v4 offset:6144
    s_waitcnt vmcnt(0)
    v_max3_u32 v60, v140, v141, v142
    v_max_u32 v60, v60, v143
    v_cmp_eq_u32 vcc, -1, v60
    s_nop 0
    s_cbranch_vccnz L_v_19_slow
L_v_19_back:
    v_lshlrev_b32 v54, 16, v33
    v_and_b32 v55, 0xffff0000, v33
    v_lshlrev_b32 v48, 16, v37
    v_and_b32 v49, 0xffff0000, v37
    v_add_f32 v54, v54, v48
    v_add_f32 v55, v55, v49
    s_waitcnt lgkmcnt(6)
    v_mfma_f32_32x32x16_bf16 v[80:95], v[144:147], v[132:135], v[80:95]
    ds_read_b64_tr_b16 v[176:177], v4 offset:16384
    ds_read_b64_tr_b16 v[178:179], v4 offset:18432
    v_lshlrev_b32 v56, 16, v34
    v_and_b32 v57, 0xffff0000, v34
    v_lshlrev_b32 v48, 16, v38
    v_and_b32 v49, 0xffff0000, v38
    v_add_f32 v56, v56, v48
    v_add_f32 v57, v57, v49
    v_mov_b32 v13, 4
    buffer_store_dword v13, v12, s[16:19], s51 offen sc1
    s_waitcnt lgkmcnt(6)
    v_mfma_f32_32x32x16_bf16 v[80:95], v[152:155], v[140:143], v[80:95]
    ds_read_b64_tr_b16 v[184:185], v4 offset:20480
    ds_read_b64_tr_b16 v[186:187], v4 offset:22528
    v_lshlrev_b32 v58, 16, v35
    v_and_b32 v59, 0xffff0000, v35
    v_lshlrev_b32 v48, 16, v39
    v_and_b32 v49, 0xffff0000, v39
    v_add_f32 v58, v58, v48
    v_add_f32 v59, v59, v49
    s_setprio 0
    s_waitcnt lgkmcnt(6)
    v_mfma_f32_32x32x16_bf16 v[96:111], v[160:163], v[228:231], v[96:111]
    ds_read_b64_tr_b16 v[128:129], v8 offset:49152
    ds_read_b64_tr_b16 v[130:131], v8 offset:51200
    s_waitcnt lgkmcnt(6)
    v_mfma_f32_32x32x16_bf16 v[96:111], v[168:171], v[236:239], v[96:111]
    ds_read_b64_tr_b16 v[136:137], v8 offset:53248
    ds_read_b64_tr_b16 v[138:139], v8 offset:55296
    ds_write_b128 v22, v[88:91] offset:16384
    ds_write_b128 v22, v[92:95] offset:17408
    s_waitcnt lgkmcnt(8)
    v_mfma_f32_32x32x16_bf16 v[96:111], v[176:179], v[244:247], v[96:111]
    ds_read_b64_tr_b16 v[144:145], v5 offset:0
    ds_read_b64_tr_b16 v[146:147], v5 offset:2048
    s_waitcnt lgkmcnt(2)
    s_barrier
    ds_read_b128 v[88:91], v25 offset:16384
    ds_read_b128 v[92:95], v25 offset:17408
    v_mfma_f32_32x32x16_bf16 v[96:111], v[184:187], v[252:255], v[96:111]
    ds_read_b64_tr_b16 v[152:153], v5 offset:4096
    ds_read_b64_tr_b16 v[154:155], v5 offset:6144
    s_setprio 3
    v_mfma_f32_32x32x16_bf16 v[96:111], v[128:131], v[132:135], v[96:111]
    ds_read_b64_tr_b16 v[160:161], v5 offset:16384
    ds_read_b64_tr_b16 v[162:163], v5 offset:18432
    s_waitcnt lgkmcnt(5)
    v_add_f32 v80, v80, v88
    v_add_f32 v81, v81, v89
    v_add_f32 v82, v82, v90
    v_add_f32 v83, v83, v91
    s_waitcnt lgkmcnt(4)
    v_add_f32 v84, v84, v92
    v_add_f32 v85, v85, v93
    v_add_f32 v86, v86, v94
    v_add_f32 v87, v87, v95
    v_cvt_pk_bf16_f32 v88, v80, v81
    v_cvt_pk_bf16_f32 v89, v82, v83
    v_cvt_pk_bf16_f32 v90, v84, v85
    v_cvt_pk_bf16_f32 v91, v86, v87
    s_xor_b32 s47, s2, 1
    s_mul_i32 s47, s47, 24576
    s_lshl_b32 s48, s3, 10
    s_add_u32 s47, s47, s48
    s_add_u32 s47, s47, 16777216
    buffer_store_dwordx4 v[88:91], v27, s[16:19], s47 offen sc1
    v_mfma_f32_32x32x16_bf16 v[96:111], v[136:139], v[140:143], v[96:111]
    ds_read_b64_tr_b16 v[168:169], v5 offset:20480
    ds_read_b64_tr_b16 v[170:171], v5 offset:22528
    v_mfma_f32_32x32x16_bf16 v[112:127], v[144:147], v[228:231], v[112:127]
    ds_read_b64_tr_b16 v[176:177], v9 offset:49152
    ds_read_b64_tr_b16 v[178:179], v9 offset:51200
    s_waitcnt lgkmcnt(6)
    v_mfma_f32_32x32x16_bf16 v[112:127], v[152:155], v[236:239], v[112:127]
    ds_read_b64_tr_b16 v[184:185], v9 offset:53248
    ds_read_b64_tr_b16 v[186:187], v9 offset:55296
    s_nop 2
    ds_write_b128 v22, v[104:107] offset:0
    ds_write_b128 v22, v[108:111] offset:1024
    s_setprio 2
    s_waitcnt lgkmcnt(8)
    v_mfma_f32_32x32x16_bf16 v[112:127], v[160:163], v[244:247], v[112:127]
    ds_read_b64_tr_b16 v[128:129], v2 offset:32768
    ds_read_b64_tr_b16 v[130:131], v2 offset:34816
    s_waitcnt lgkmcnt(2)
    s_barrier
    ds_read_b128 v[104:107], v25 offset:0
    ds_read_b128 v[108:111], v25 offset:1024
    v_mfma_f32_32x32x16_bf16 v[112:127], v[168:171], v[252:255], v[112:127]
    ds_read_b64_tr_b16 v[136:137], v2 offset:36864
    ds_read_b64_tr_b16 v[138:139], v2 offset:38912
    v_mfma_f32_32x32x16_bf16 v[112:127], v[176:179], v[132:135], v[112:127]
    ds_read_b64_tr_b16 v[144:145], v2 offset:49152
    ds_read_b64_tr_b16 v[146:147], v2 offset:51200
    s_waitcnt lgkmcnt(5)
    v_add_f32 v96, v96, v104
    v_add_f32 v97, v97, v105
    v_add_f32 v98, v98, v106
    v_add_f32 v99, v99, v107
    s_waitcnt lgkmcnt(4)
    v_add_f32 v100, v100, v108
    v_add_f32 v101, v101, v109
    v_add_f32 v102, v102, v110
    v_add_f32 v103, v103, v111
    v_cvt_pk_bf16_f32 v104, v96, v97
    v_cvt_pk_bf16_f32 v105, v98, v99
    v_cvt_pk_bf16_f32 v106, v100, v101
    v_cvt_pk_bf16_f32 v107, v102, v103
    s_xor_b32 s47, s2, 2
    s_mul_i32 s47, s47, 24576
    s_lshl_b32 s48, s3, 10
    s_add_u32 s47, s47, s48
    s_add_u32 s47, s47, 16785408
    buffer_store_dwordx4 v[104:107], v27, s[16:19], s47 offen sc1
    v_mfma_f32_32x32x16_bf16 v[112:127], v[184:187], v[140:143], v[112:127]
    ds_read_b64_tr_b16 v[152:153], v2 offset:53248
    ds_read_b64_tr_b16 v[154:155], v2 offset:55296
    s_setprio 1
    v_mfma_f32_32x32x16_bf16 v[64:79], v[128:131], v[148:151], v[64:79]
    ds_read_b64_tr_b16 v[160:161], v6 offset:0
    ds_read_b64_tr_b16 v[162:163], v6 offset:2048
    s_waitcnt lgkmcnt(6)
    v_mfma_f32_32x32x16_bf16 v[64:79], v[136:139], v[156:159], v[64:79]
    ds_read_b64_tr_b16 v[168:169], v6 offset:4096
    ds_read_b64_tr_b16 v[170:171], v6 offset:6144
    s_nop 1
    ds_write_b128 v22, v[120:123] offset:16384
    ds_write_b128 v22, v[124:127] offset:17408
    s_waitcnt lgkmcnt(8)
    v_mfma_f32_32x32x16_bf16 v[64:79], v[144:147], v[164:167], v[64:79]
    ds_read_b64_tr_b16 v[176:177], v6 offset:16384
    ds_read_b64_tr_b16 v[178:179], v6 offset:18432
    s_waitcnt lgkmcnt(2)
    s_barrier
    ds_read_b128 v[120:123], v25 offset:16384
    ds_read_b128 v[124:127], v25 offset:17408
    v_mfma_f32_32x32x16_bf16 v[64:79], v[152:155], v[172:175], v[64:79]
    ds_read_b64_tr_b16 v[184:185], v6 offset:20480
    ds_read_b64_tr_b16 v[186:187], v6 offset:22528
    v_and_b32 v29, 3, v1
    v_lshlrev_b32 v29, 8, v29
    v_xor_b32 v29, s51, v29
    buffer_load_dword v28, v29, s[16:19], 0 offen sc1
    s_setprio 0
    v_mfma_f32_32x32x16_bf16 v[64:79], v[160:163], v[180:183], v[64:79]
    ds_read_b64_tr_b16 v[128:129], v6 offset:32768
    ds_read_b64_tr_b16 v[130:131], v6 offset:34816
    s_waitcnt lgkmcnt(5)
    v_add_f32 v112, v112, v120
    v_add_f32 v113, v113, v121
    v_add_f32 v114, v114, v122
    v_add_f32 v115, v115, v123
    s_waitcnt lgkmcnt(4)
    v_add_f32 v116, v116, v124
    v_add_f32 v117, v117, v125
    v_add_f32 v118, v118, v126
    v_add_f32 v119, v119, v127
    v_cvt_pk_bf16_f32 v120, v112, v113
    v_cvt_pk_bf16_f32 v121, v114, v115
    v_cvt_pk_bf16_f32 v122, v116, v117
    v_cvt_pk_bf16_f32 v123, v118, v119
    s_xor_b32 s47, s2, 3
    s_mul_i32 s47, s47, 24576
    s_lshl_b32 s48, s3, 10
    s_add_u32 s47, s47, s48
    s_add_u32 s47, s47, 16793600
    buffer_store_dwordx4 v[120:123], v27, s[16:19], s47 offen sc1
    v_mfma_f32_32x32x16_bf16 v[64:79], v[168:171], v[188:191], v[64:79]
    ds_read_b64_tr_b16 v[136:137], v6 offset:36864
    ds_read_b64_tr_b16 v[138:139], v6 offset:38912
    v_mfma_f32_32x32x16_bf16 v[64:79], v[176:179], v[196:199], v[64:79]
    ds_read_b64_tr_b16 v[144:145], v2 offset:0
    ds_read_b64_tr_b16 v[146:147], v2 offset:2048
    s_waitcnt lgkmcnt(6)
    v_mfma_f32_32x32x16_bf16 v[64:79], v[184:187], v[204:207], v[64:79]
    ds_read_b64_tr_b16 v[152:153], v2 offset:4096
    ds_read_b64_tr_b16 v[154:155], v2 offset:6144
    s_setprio 3
    s_waitcnt lgkmcnt(6)
    v_mfma_f32_32x32x16_bf16 v[64:79], v[128:131], v[212:215], v[64:79]
    ds_read_b64_tr_b16 v[160:161], v2 offset:16384
    ds_read_b64_tr_b16 v[162:163], v2 offset:18432
    s_waitcnt lgkmcnt(6)
    v_mfma_f32_32x32x16_bf16 v[64:79], v[136:139], v[220:223], v[64:79]
    ds_read_b64_tr_b16 v[168:169], v2 offset:20480
    ds_read_b64_tr_b16 v[170:171], v2 offset:22528
    s_waitcnt lgkmcnt(6)
    v_mfma_f32_32x32x16_bf16 v[64:79], v[144:147], v[228:231], v[64:79]
    ds_read_b64_tr_b16 v[176:177], v6 offset:49152
    ds_read_b64_tr_b16 v[178:179], v6 offset:51200
    s_waitcnt lgkmcnt(6)
    v_mfma_f32_32x32x16_bf16 v[64:79], v[152:155], v[236:239], v[64:79]
    ds_read_b64_tr_b16 v[184:185], v6 offset:53248
    ds_read_b64_tr_b16 v[186:187], v6 offset:55296
    s_setprio 2
    s_waitcnt lgkmcnt(6)
    v_mfma_f32_32x32x16_bf16 v[64:79], v[160:163], v[244:247], v[64:79]
    s_waitcnt lgkmcnt(4)
    v_mfma_f32_32x32x16_bf16 v[64:79], v[168:171], v[252:255], v[64:79]
    s_waitcnt lgkmcnt(2)
    v_mfma_f32_32x32x16_bf16 v[64:79], v[176:179], v[132:135], v[64:79]
    s_waitcnt lgkmcnt(0)
    v_mfma_f32_32x32x16_bf16 v[64:79], v[184:187], v[140:143], v[64:79]
    s_setprio 0
    s_nop 10
    ds_write_b128 v22, v[72:75] offset:0
    ds_write_b128 v22, v[76:79] offset:1024
    s_waitcnt vmcnt(1)
    v_mov_b32 v28, v28
    s_mov_b32 s57, 0
L_pf_20:
    v_cmp_gt_u32 vcc, 4, v28
    s_add_u32 s57, s57, 1
    s_cbranch_vccz L_pf_20_ok
    s_cmp_gt_u32 s57, 32768
    s_cbranch_scc1 L_pf_20_ok
    s_sleep 1
    buffer_load_dword v28, v29, s[16:19], 0 offen sc1
    s_waitcnt vmcnt(0)
    s_branch L_pf_20
L_pf_20_ok:
    s_waitcnt lgkmcnt(0)
    s_barrier
    ds_read_b128 v[72:75], v25 offset:0
    ds_read_b128 v[76:79], v25 offset:1024
    s_mul_i32 s47, s2, 24576
    s_lshl_b32 s48, s3, 10
    s_add_u32 s47, s47, s48
    s_add_u32 s47, s47, 16777216
    buffer_load_dwordx4 v[192:195], v27, s[16:19], s47 offen sc1
    s_mul_i32 s47, s2, 24576
    s_lshl_b32 s48, s3, 10
    s_add_u32 s47, s47, s48
    s_add_u32 s47, s47, 16785408
    buffer_load_dwordx4 v[200:203], v27, s[16:19], s47 offen sc1
    s_mul_i32 s47, s2, 24576
    s_lshl_b32 s48, s3, 10
    s_add_u32 s47, s47, s48
    s_add_u32 s47, s47, 16793600
    buffer_load_dwordx4 v[208:211], v27, s[16:19], s47 offen sc1
    s_waitcnt lgkmcnt(1)
    v_pk_add_f32 v[64:65], v[64:65], v[72:73]
    v_pk_add_f32 v[66:67], v[66:67], v[74:75]
    s_waitcnt lgkmcnt(0)
    v_pk_add_f32 v[68:69], v[68:69], v[76:77]
    v_pk_add_f32 v[70:71], v[70:71], v[78:79]
    s_waitcnt vmcnt(2)
    v_max3_u32 v60, v192, v193, v194
    s_waitcnt vmcnt(1)
    v_max3_u32 v60, v60, v195, v200
    v_max3_u32 v60, v60, v201, v202
    s_waitcnt vmcnt(0)
    v_max3_u32 v60, v60, v203, v208
    v_max3_u32 v60, v60, v209, v210
    v_max_u32 v60, v60, v211
    v_cmp_eq_u32 vcc, -1, v60
    s_nop 0
    s_cbranch_vccnz L_v_21_slow
L_v_21_back:
    s_mov_b32 s47, 0x3f80
    s_mov_b32 s48, 0x3f800000
    v_dot2c_f32_bf16 v64, s47, v192
    v_dot2c_f32_bf16 v65, s48, v192
    v_dot2c_f32_bf16 v66, s47, v193
    v_dot2c_f32_bf16 v67, s48, v193
    v_dot2c_f32_bf16 v68, s47, v194
    v_dot2c_f32_bf16 v69, s48, v194
    v_dot2c_f32_bf16 v70, s47, v195
    v_dot2c_f32_bf16 v71, s48, v195
    v_dot2c_f32_bf16 v64, s47, v200
    v_dot2c_f32_bf16 v65, s48, v200
    v_dot2c_f32_bf16 v66, s47, v201
    v_dot2c_f32_bf16 v67, s48, v201
    v_dot2c_f32_bf16 v68, s47, v202
    v_dot2c_f32_bf16 v69, s48, v202
    v_dot2c_f32_bf16 v70, s47, v203
    v_dot2c_f32_bf16 v71, s48, v203
    v_dot2c_f32_bf16 v64, s47, v208
    v_dot2c_f32_bf16 v65, s48, v208
    v_dot2c_f32_bf16 v66, s47, v209
    v_dot2c_f32_bf16 v67, s48, v209
    v_dot2c_f32_bf16 v68, s47, v210
    v_dot2c_f32_bf16 v69, s48, v210
    v_dot2c_f32_bf16 v70, s47, v211
    v_dot2c_f32_bf16 v71, s48, v211
    v_permlane32_swap_b32 v64, v68
    v_permlane32_swap_b32 v65, v69
    v_permlane32_swap_b32 v66, v70
    v_permlane32_swap_b32 v67, v71
    v_pk_add_f32 v[52:53], v[52:53], v[64:65]
    v_pk_add_f32 v[54:55], v[54:55], v[66:67]
    v_pk_add_f32 v[56:57], v[56:57], v[68:69]
    v_pk_add_f32 v[58:59], v[58:59], v[70:71]
    v_cvt_pk_bf16_f32 v32, v52, v53
    v_cvt_pk_bf16_f32 v33, v54, v55
    v_cvt_pk_bf16_f32 v34, v56, v57
    v_cvt_pk_bf16_f32 v35, v58, v59
    buffer_store_dwordx4 v[32:35], v16, s[40:43], s45 offen
    s_endpgm
L_v_16_slow:
    s_mov_b32 s57, 0
L_v_16_loop:
    s_sleep 2
    s_add_u32 s101, s98, 0
    s_and_b32 s101, s101, 3
    s_lshl_b32 s101, s101, 10
    s_add_u32 s101, s101, s97
    buffer_load_dwordx4 v[244:247], v27, s[16:19], s101 offen sc1
    s_waitcnt vmcnt(0)
    v_max3_u32 v60, v244, v245, v246
    v_max_u32 v60, v60, v247
    v_cmp_eq_u32 vcc, -1, v60
    s_add_u32 s57, s57, 1
    s_cbranch_vccz L_v_16_back
    s_cmp_gt_u32 s57, 32768
    s_cbranch_scc0 L_v_16_loop
    s_branch L_v_16_back
L_v_17_slow:
    s_mov_b32 s57, 0
L_v_17_loop:
    s_sleep 2
    s_add_u32 s101, s98, 1
    s_and_b32 s101, s101, 3
    s_lshl_b32 s101, s101, 10
    s_add_u32 s101, s101, s97
    buffer_load_dwordx4 v[252:255], v27, s[16:19], s101 offen sc1
    s_waitcnt vmcnt(0)
    v_max3_u32 v60, v252, v253, v254
    v_max_u32 v60, v60, v255
    v_cmp_eq_u32 vcc, -1, v60
    s_add_u32 s57, s57, 1
    s_cbranch_vccz L_v_17_back
    s_cmp_gt_u32 s57, 32768
    s_cbranch_scc0 L_v_17_loop
    s_branch L_v_17_back
L_v_18_slow:
    s_mov_b32 s57, 0
L_v_18_loop:
    s_sleep 2
    s_add_u32 s101, s98, 2
    s_and_b32 s101, s101, 3
    s_lshl_b32 s101, s101, 10
    s_add_u32 s101, s101, s97
    buffer_load_dwordx4 v[132:135], v27, s[16:19], s101 offen sc1
    s_waitcnt vmcnt(0)
    v_max3_u32 v60, v132, v133, v134
    v_max_u32 v60, v60, v135
    v_cmp_eq_u32 vcc, -1, v60
    s_add_u32 s57, s57, 1
    s_cbranch_vccz L_v_18_back
    s_cmp_gt_u32 s57, 32768
    s_cbranch_scc0 L_v_18_loop
    s_branch L_v_18_back
L_v_19_slow:
    s_mov_b32 s57, 0
L_v_19_loop:
    s_sleep 2
    s_add_u32 s101, s98, 3
    s_and_b32 s101, s101, 3
    s_lshl_b32 s101, s101, 10
    s_add_u32 s101, s101, s97
    buffer_load_dwordx4 v[140:143], v27, s[16:19], s101 offen sc1
    s_waitcnt vmcnt(0)
    v_max3_u32 v60, v140, v141, v142
    v_max_u32 v60, v60, v143
    v_cmp_eq_u32 vcc, -1, v60
    s_add_u32 s57, s57, 1
    s_cbranch_vccz L_v_19_back
    s_cmp_gt_u32 s57, 32768
    s_cbranch_scc0 L_v_19_loop
    s_branch L_v_19_back
L_v_21_slow:
    s_mov_b32 s57, 0
L_v_21_loop:
    s_sleep 2
    s_mul_i32 s47, s2, 24576
    s_lshl_b32 s48, s3, 10
    s_add_u32 s47, s47, s48
    s_add_u32 s47, s47, 16777216
    buffer_load_dwordx4 v[192:195], v27, s[16:19], s47 offen sc1
    s_mul_i32 s47, s2, 24576
    s_lshl_b32 s48, s3, 10
    s_add_u32 s47, s47, s48
    s_add_u32 s47, s47, 16785408
    buffer_load_dwordx4 v[200:203], v27, s[16:19], s47 offen sc1
    s_mul_i32 s47, s2, 24576
    s_lshl_b32 s48, s3, 10
    s_add_u32 s47, s47, s48
    s_add_u32 s47, s47, 16793600
    buffer_load_dwordx4 v[208:211], v27, s[16:19], s47 offen sc1
    s_waitcnt vmcnt(0)
    v_max3_u32 v60, v192, v193, v194
    v_max3_u32 v60, v60, v195, v200
    v_max3_u32 v60, v60, v201, v202
    v_max3_u32 v60, v60, v203, v208
    v_max3_u32 v60, v60, v209, v210
    v_max_u32 v60, v60, v211
    v_cmp_eq_u32 vcc, -1, v60
    s_add_u32 s57, s57, 1
    s_cbranch_vccz L_v_21_back
    s_cmp_gt_u32 s57, 32768
    s_cbranch_scc0 L_v_21_loop
    s_branch L_v_21_back
L_end:
    s_endpgm
.section .rodata,"a"
.p2align 6
.amdhsa_kernel parallel_sum__linear_kernel_hedgehog__dense_activation_gelu__prompt_kernel
  .amdhsa_next_free_vgpr 256
  .amdhsa_next_free_sgpr 102
  .amdhsa_accum_offset 256
  .amdhsa_group_segment_fixed_size 0
  .amdhsa_kernarg_size 96
  .amdhsa_user_sgpr_count 2
  .amdhsa_user_sgpr_kernarg_segment_ptr 1
  .amdhsa_system_sgpr_workgroup_id_x 1
.end_amdhsa_kernel
```
